```python
import torch

def _softmax(x, axis=-1):
    return torch.softmax(x, dim=axis)
def _gelu(x):
    return torch.nn.functional.gelu(x, approximate="tanh")
def _silu(x):
    return torch.nn.functional.silu(x)
def _sigmoid(x):
    return torch.sigmoid(x)
def _layernorm(x, axis=-1, eps=1e-5):
    m = x.mean(dim=axis, keepdim=True)
    v = x.var(dim=axis, keepdim=True, unbiased=False)
    return (x - m) / torch.sqrt(v + eps)
def _scatter_add(tgt, idx, src, axis=0):
    return tgt.clone().index_add_(axis, idx, src)
def _segment_sum(src, seg, n):
    out = torch.zeros((n,) + src.shape[1:], dtype=src.dtype)
    return out.index_add_(0, seg, src)
def _pad(x, pw):
    flat = tuple(v for pair in reversed(pw) for v in pair)
    return torch.nn.functional.pad(x, flat)

kernel_name = 'gated_mix__ssm_conv_h3__dense_activation_mish__prompt'

def setup_inputs():

    _w = (lambda a: (lambda t: t.to(torch.bfloat16) if t.is_floating_point() else t)(torch.as_tensor(a)))
    def _A_setup():
        B, S, D = 1, 2048, 512
        ks = 4
        return {
            "q": _w((lambda *s: torch.randn(*s, dtype=torch.bfloat16) * 0.05)(B, S, D)),
            "k": _w((lambda *s: torch.randn(*s, dtype=torch.bfloat16) * 0.2)(B, S, D)),
            "v": _w((lambda *s: torch.randn(*s, dtype=torch.bfloat16) * 0.2)(B, S, D)),
            "shift_k": _w((lambda *s: torch.randn(*s, dtype=torch.bfloat16) * 0.2)(D, ks) * 0.5),
            "ssm_k": _w((lambda *s: torch.randn(*s, dtype=torch.bfloat16) * 0.8)(D, S) * (1.0 / S ** 0.5)),
            "ssm_D": _w((lambda *s: torch.randn(*s, dtype=torch.bfloat16) * 0.2)(D)),
        }
    _A_in = _A_setup()

    def _B_setup():
        B, S, D, F = 1, 2048, 512, 1376
        return {
            "x": _w((lambda *s: torch.randn(*s, dtype=torch.bfloat16) * 0.05)(B, S, D)),
            "w1": _w((lambda *s: torch.randn(*s, dtype=torch.bfloat16) * 3.2)(D, F) * (D ** -0.5)),
            "b1": _w((lambda *s: torch.randn(*s, dtype=torch.bfloat16) * 0.05)(F)),
            "w2": _w((lambda *s: torch.randn(*s, dtype=torch.bfloat16) * 0.05)(F, D) * (F ** -0.5)),
        }
    _B_in = _B_setup()

    return {
        "A_q": _A_in["q"],
        "A_k": _A_in["k"],
        "A_v": _A_in["v"],
        "A_shift_k": _A_in["shift_k"],
        "A_ssm_k": _A_in["ssm_k"],
        "A_ssm_D": _A_in["ssm_D"],
        "B_x": _B_in["x"],
        "B_w1": _B_in["w1"],
        "B_b1": _B_in["b1"],
        "B_w2": _B_in["w2"],
        "gate_w": _w((lambda *s: torch.randn(*s, dtype=torch.bfloat16) * 0.05)(512) * 16.0),
    }

def reference(A_q, A_k, A_v, A_shift_k, A_ssm_k, A_ssm_D, B_x, B_w1, B_b1, B_w2, gate_w):
    def _A_ref(q, k, v, shift_k, ssm_k, ssm_D):
        B, S, D = q.shape
        ks = shift_k.shape[-1]
        k_pad = _pad(k, ((0, 0), (ks - 1, 0), (0, 0)))
        k_shift = torch.zeros_like(k)
        for t in range(ks):
            k_shift = k_shift + k_pad[:, t:t + S, :] * shift_k[:, ks - 1 - t][None, None, :]
        kv = k_shift * v
        L = 2 * S
        kv_pad = _pad(kv, ((0, 0), (0, S), (0, 0)))
        kf_pad = _pad(ssm_k, ((0, 0), (0, S)))
        kv_f = (lambda x, axes=(-2,-1): torch.fft.rfft2(x.float(), dim=axes))(kv_pad[:, None, :, :], axes=(1, 2))
        kf_f = (lambda x, axes=(-2,-1): torch.fft.rfft2(x.float(), dim=axes))(kf_pad[:, None, :], axes=(1, 2))
        kf_f = (lambda x, *d: x.permute(*d))(kf_f, 1, 2, 0)
        y_f = kv_f * kf_f[None, :, :, :]
        y = (lambda x, s, axes=(-2,-1): torch.fft.irfft2(x, s=s, dim=axes).to(torch.bfloat16))(y_f, (1, L), axes=(1, 2))[:, 0, :S, :]
        y = y + kv * ssm_D[None, None, :]
        return q * y

    def _B_ref(x, w1, b1, w2):
        h = torch.einsum("bsd,df->bsf", x, w1) + b1
        sp = torch.log1p(torch.exp(-torch.abs(h))) + torch.where(h > 0, h, torch.zeros_like(h))
        act = h * torch.tanh(sp)
        return torch.einsum("bsf,fd->bsd", act, w2)

    x = A_q
    g = _sigmoid((x * gate_w).sum(-1, keepdims=True))
    a = _A_ref(x, A_k, A_v, A_shift_k, A_ssm_k, A_ssm_D)
    b = _B_ref(x, B_w1, B_b1, B_w2)
    return g * a + (1 - g) * b
```

```asm
; @launch kernel=prep_kernel grid=(1080,1,1) block=(256,1,1) lds=16384
; @launch kernel=mid_kernel grid=(496,1,1) block=(256,1,1) lds=57344
; @launch kernel=gemm2_kernel grid=(256,1,1) block=(256,1,1) lds=49152
.amdgcn_target "amdgcn-amd-amdhsa--gfx950"
.text
.globl prep_kernel
.p2align 8
.type prep_kernel,@function
prep_kernel:
    s_cmp_ge_u32 s2, 1080
    s_cbranch_scc1 L_prep_exit
    s_load_dwordx2 s[6:7], s[0:1], 104
    s_cmp_ge_u32 s2, 256
    s_cbranch_scc1 L_prep_gate
    s_load_dwordx2 s[4:5], s[0:1], 8
    s_load_dwordx2 s[24:25], s[0:1], 16
    s_load_dwordx2 s[26:27], s[0:1], 24
    s_lshr_b32 s3, s2, 3
    s_lshl_b32 s3, s3, 6
    s_and_b32 s28, s2, 7
    s_lshl_b32 s28, s28, 6
    v_lshrrev_b32 v1, 3, v0
    v_and_b32 v2, 7, v0
    v_lshlrev_b32 v3, 4, v2
    s_lshl_b32 s29, s28, 1
    v_add_u32 v3, s29, v3
    s_waitcnt lgkmcnt(0)
    s_mov_b32 s8, s4
    s_mov_b32 s9, s5
    s_mov_b32 s10, 0x200000
    s_mov_b32 s11, 0x00020000
    s_mov_b32 s12, s24
    s_mov_b32 s13, s25
    s_mov_b32 s14, 0x200000
    s_mov_b32 s15, 0x00020000
    s_mov_b32 s16, s26
    s_mov_b32 s17, s27
    s_mov_b32 s18, 0x1000
    s_mov_b32 s19, 0x00020000
    s_mov_b32 s20, s6
    s_mov_b32 s21, s7
    s_mov_b32 s22, 0x200000
    s_mov_b32 s23, 0x00020000
    v_lshlrev_b32 v4, 2, v3
    buffer_load_dwordx4 v[16:19], v4, s[16:19], 0 offen offset:0
    buffer_load_dwordx4 v[20:23], v4, s[16:19], 0 offen offset:16
    buffer_load_dwordx4 v[24:27], v4, s[16:19], 0 offen offset:32
    buffer_load_dwordx4 v[28:31], v4, s[16:19], 0 offen offset:48
    v_mul_u32_u24 v9, 1152, v2
    s_waitcnt vmcnt(0)
    v_lshlrev_b32 v32, 16, v16
    v_and_b32 v33, 0xffff0000, v16
    v_lshlrev_b32 v34, 16, v17
    v_and_b32 v35, 0xffff0000, v17
    v_lshlrev_b32 v36, 16, v18
    v_and_b32 v37, 0xffff0000, v18
    v_lshlrev_b32 v38, 16, v19
    v_and_b32 v39, 0xffff0000, v19
    v_lshlrev_b32 v40, 16, v20
    v_and_b32 v41, 0xffff0000, v20
    v_lshlrev_b32 v42, 16, v21
    v_and_b32 v43, 0xffff0000, v21
    v_lshlrev_b32 v44, 16, v22
    v_and_b32 v45, 0xffff0000, v22
    v_lshlrev_b32 v46, 16, v23
    v_and_b32 v47, 0xffff0000, v23
    v_lshlrev_b32 v48, 16, v24
    v_and_b32 v49, 0xffff0000, v24
    v_lshlrev_b32 v50, 16, v25
    v_and_b32 v51, 0xffff0000, v25
    v_lshlrev_b32 v52, 16, v26
    v_and_b32 v53, 0xffff0000, v26
    v_lshlrev_b32 v54, 16, v27
    v_and_b32 v55, 0xffff0000, v27
    v_lshlrev_b32 v56, 16, v28
    v_and_b32 v57, 0xffff0000, v28
    v_lshlrev_b32 v58, 16, v29
    v_and_b32 v59, 0xffff0000, v29
    v_lshlrev_b32 v60, 16, v30
    v_and_b32 v61, 0xffff0000, v30
    v_lshlrev_b32 v62, 16, v31
    v_and_b32 v63, 0xffff0000, v31
    v_add_u32 v5, s3, v1
    v_add_u32 v5, -3, v5
    v_lshlrev_b32 v5, 10, v5
    v_add_u32 v5, v5, v3
    v_add_u32 v6, 0x400, v5
    v_add_u32 v7, 0x800, v5
    v_add_u32 v8, 0xc00, v5
    buffer_load_dwordx4 v[64:67], v5, s[8:11], 0 offen
    buffer_load_dwordx4 v[68:71], v6, s[8:11], 0 offen
    buffer_load_dwordx4 v[72:75], v7, s[8:11], 0 offen
    buffer_load_dwordx4 v[76:79], v8, s[8:11], 0 offen
    buffer_load_dwordx4 v[80:83], v8, s[12:15], 0 offen
    v_add_u32 v5, s3, v1
    v_add_u32 v5, 29, v5
    v_lshlrev_b32 v5, 10, v5
    v_add_u32 v5, v5, v3
    v_add_u32 v6, 0x400, v5
    v_add_u32 v7, 0x800, v5
    v_add_u32 v8, 0xc00, v5
    buffer_load_dwordx4 v[100:103], v5, s[8:11], 0 offen
    buffer_load_dwordx4 v[104:107], v6, s[8:11], 0 offen
    buffer_load_dwordx4 v[108:111], v7, s[8:11], 0 offen
    buffer_load_dwordx4 v[112:115], v8, s[8:11], 0 offen
    buffer_load_dwordx4 v[116:119], v8, s[12:15], 0 offen
    s_waitcnt vmcnt(5)
    v_lshlrev_b32 v84, 16, v64
    v_and_b32 v85, 0xffff0000, v64
    v_mul_f32 v84, v84, v35
    v_mul_f32 v85, v85, v39
    v_cvt_pk_bf16_f32 v86, v84, v85
    v_lshlrev_b32 v87, 16, v86
    v_and_b32 v88, 0xffff0000, v86
    v_lshlrev_b32 v84, 16, v68
    v_and_b32 v85, 0xffff0000, v68
    v_mul_f32 v84, v84, v34
    v_mul_f32 v85, v85, v38
    v_cvt_pk_bf16_f32 v86, v84, v85
    v_lshlrev_b32 v84, 16, v86
    v_and_b32 v85, 0xffff0000, v86
    v_add_f32 v87, v87, v84
    v_add_f32 v88, v88, v85
    v_cvt_pk_bf16_f32 v86, v87, v88
    v_lshlrev_b32 v87, 16, v86
    v_and_b32 v88, 0xffff0000, v86
    v_lshlrev_b32 v84, 16, v72
    v_and_b32 v85, 0xffff0000, v72
    v_mul_f32 v84, v84, v33
    v_mul_f32 v85, v85, v37
    v_cvt_pk_bf16_f32 v86, v84, v85
    v_lshlrev_b32 v84, 16, v86
    v_and_b32 v85, 0xffff0000, v86
    v_add_f32 v87, v87, v84
    v_add_f32 v88, v88, v85
    v_cvt_pk_bf16_f32 v86, v87, v88
    v_lshlrev_b32 v87, 16, v86
    v_and_b32 v88, 0xffff0000, v86
    v_lshlrev_b32 v84, 16, v76
    v_and_b32 v85, 0xffff0000, v76
    v_mul_f32 v84, v84, v32
    v_mul_f32 v85, v85, v36
    v_cvt_pk_bf16_f32 v86, v84, v85
    v_lshlrev_b32 v84, 16, v86
    v_and_b32 v85, 0xffff0000, v86
    v_add_f32 v87, v87, v84
    v_add_f32 v88, v88, v85
    v_cvt_pk_bf16_f32 v86, v87, v88
    v_lshlrev_b32 v87, 16, v86
    v_and_b32 v88, 0xffff0000, v86
    v_lshlrev_b32 v84, 16, v80
    v_and_b32 v85, 0xffff0000, v80
    v_mul_f32 v87, v87, v84
    v_mul_f32 v88, v88, v85
    v_cvt_pk_bf16_f32 v90, v87, v88
    v_lshlrev_b32 v84, 16, v65
    v_and_b32 v85, 0xffff0000, v65
    v_mul_f32 v84, v84, v43
    v_mul_f32 v85, v85, v47
    v_cvt_pk_bf16_f32 v86, v84, v85
    v_lshlrev_b32 v87, 16, v86
    v_and_b32 v88, 0xffff0000, v86
    v_lshlrev_b32 v84, 16, v69
    v_and_b32 v85, 0xffff0000, v69
    v_mul_f32 v84, v84, v42
    v_mul_f32 v85, v85, v46
    v_cvt_pk_bf16_f32 v86, v84, v85
    v_lshlrev_b32 v84, 16, v86
    v_and_b32 v85, 0xffff0000, v86
    v_add_f32 v87, v87, v84
    v_add_f32 v88, v88, v85
    v_cvt_pk_bf16_f32 v86, v87, v88
    v_lshlrev_b32 v87, 16, v86
    v_and_b32 v88, 0xffff0000, v86
    v_lshlrev_b32 v84, 16, v73
    v_and_b32 v85, 0xffff0000, v73
    v_mul_f32 v84, v84, v41
    v_mul_f32 v85, v85, v45
    v_cvt_pk_bf16_f32 v86, v84, v85
    v_lshlrev_b32 v84, 16, v86
    v_and_b32 v85, 0xffff0000, v86
    v_add_f32 v87, v87, v84
    v_add_f32 v88, v88, v85
    v_cvt_pk_bf16_f32 v86, v87, v88
    v_lshlrev_b32 v87, 16, v86
    v_and_b32 v88, 0xffff0000, v86
    v_lshlrev_b32 v84, 16, v77
    v_and_b32 v85, 0xffff0000, v77
    v_mul_f32 v84, v84, v40
    v_mul_f32 v85, v85, v44
    v_cvt_pk_bf16_f32 v86, v84, v85
    v_lshlrev_b32 v84, 16, v86
    v_and_b32 v85, 0xffff0000, v86
    v_add_f32 v87, v87, v84
    v_add_f32 v88, v88, v85
    v_cvt_pk_bf16_f32 v86, v87, v88
    v_lshlrev_b32 v87, 16, v86
    v_and_b32 v88, 0xffff0000, v86
    v_lshlrev_b32 v84, 16, v81
    v_and_b32 v85, 0xffff0000, v81
    v_mul_f32 v87, v87, v84
    v_mul_f32 v88, v88, v85
    v_cvt_pk_bf16_f32 v91, v87, v88
    v_lshlrev_b32 v84, 16, v66
    v_and_b32 v85, 0xffff0000, v66
    v_mul_f32 v84, v84, v51
    v_mul_f32 v85, v85, v55
    v_cvt_pk_bf16_f32 v86, v84, v85
    v_lshlrev_b32 v87, 16, v86
    v_and_b32 v88, 0xffff0000, v86
    v_lshlrev_b32 v84, 16, v70
    v_and_b32 v85, 0xffff0000, v70
    v_mul_f32 v84, v84, v50
    v_mul_f32 v85, v85, v54
    v_cvt_pk_bf16_f32 v86, v84, v85
    v_lshlrev_b32 v84, 16, v86
    v_and_b32 v85, 0xffff0000, v86
    v_add_f32 v87, v87, v84
    v_add_f32 v88, v88, v85
    v_cvt_pk_bf16_f32 v86, v87, v88
    v_lshlrev_b32 v87, 16, v86
    v_and_b32 v88, 0xffff0000, v86
    v_lshlrev_b32 v84, 16, v74
    v_and_b32 v85, 0xffff0000, v74
    v_mul_f32 v84, v84, v49
    v_mul_f32 v85, v85, v53
    v_cvt_pk_bf16_f32 v86, v84, v85
    v_lshlrev_b32 v84, 16, v86
    v_and_b32 v85, 0xffff0000, v86
    v_add_f32 v87, v87, v84
    v_add_f32 v88, v88, v85
    v_cvt_pk_bf16_f32 v86, v87, v88
    v_lshlrev_b32 v87, 16, v86
    v_and_b32 v88, 0xffff0000, v86
    v_lshlrev_b32 v84, 16, v78
    v_and_b32 v85, 0xffff0000, v78
    v_mul_f32 v84, v84, v48
    v_mul_f32 v85, v85, v52
    v_cvt_pk_bf16_f32 v86, v84, v85
    v_lshlrev_b32 v84, 16, v86
    v_and_b32 v85, 0xffff0000, v86
    v_add_f32 v87, v87, v84
    v_add_f32 v88, v88, v85
    v_cvt_pk_bf16_f32 v86, v87, v88
    v_lshlrev_b32 v87, 16, v86
    v_and_b32 v88, 0xffff0000, v86
    v_lshlrev_b32 v84, 16, v82
    v_and_b32 v85, 0xffff0000, v82
    v_mul_f32 v87, v87, v84
    v_mul_f32 v88, v88, v85
    v_cvt_pk_bf16_f32 v92, v87, v88
    v_lshlrev_b32 v84, 16, v67
    v_and_b32 v85, 0xffff0000, v67
    v_mul_f32 v84, v84, v59
    v_mul_f32 v85, v85, v63
    v_cvt_pk_bf16_f32 v86, v84, v85
    v_lshlrev_b32 v87, 16, v86
    v_and_b32 v88, 0xffff0000, v86
    v_lshlrev_b32 v84, 16, v71
    v_and_b32 v85, 0xffff0000, v71
    v_mul_f32 v84, v84, v58
    v_mul_f32 v85, v85, v62
    v_cvt_pk_bf16_f32 v86, v84, v85
    v_lshlrev_b32 v84, 16, v86
    v_and_b32 v85, 0xffff0000, v86
    v_add_f32 v87, v87, v84
    v_add_f32 v88, v88, v85
    v_cvt_pk_bf16_f32 v86, v87, v88
    v_lshlrev_b32 v87, 16, v86
    v_and_b32 v88, 0xffff0000, v86
    v_lshlrev_b32 v84, 16, v75
    v_and_b32 v85, 0xffff0000, v75
    v_mul_f32 v84, v84, v57
    v_mul_f32 v85, v85, v61
    v_cvt_pk_bf16_f32 v86, v84, v85
    v_lshlrev_b32 v84, 16, v86
    v_and_b32 v85, 0xffff0000, v86
    v_add_f32 v87, v87, v84
    v_add_f32 v88, v88, v85
    v_cvt_pk_bf16_f32 v86, v87, v88
    v_lshlrev_b32 v87, 16, v86
    v_and_b32 v88, 0xffff0000, v86
    v_lshlrev_b32 v84, 16, v79
    v_and_b32 v85, 0xffff0000, v79
    v_mul_f32 v84, v84, v56
    v_mul_f32 v85, v85, v60
    v_cvt_pk_bf16_f32 v86, v84, v85
    v_lshlrev_b32 v84, 16, v86
    v_and_b32 v85, 0xffff0000, v86
    v_add_f32 v87, v87, v84
    v_add_f32 v88, v88, v85
    v_cvt_pk_bf16_f32 v86, v87, v88
    v_lshlrev_b32 v87, 16, v86
    v_and_b32 v88, 0xffff0000, v86
    v_lshlrev_b32 v84, 16, v83
    v_and_b32 v85, 0xffff0000, v83
    v_mul_f32 v87, v87, v84
    v_mul_f32 v88, v88, v85
    v_cvt_pk_bf16_f32 v93, v87, v88
    v_sub_u32 v10, 63, v1
    v_lshl_add_u32 v10, v10, 1, v9
    ds_write_b16 v10, v90 offset:0
    ds_write_b16_d16_hi v10, v90 offset:144
    ds_write_b16 v10, v91 offset:288
    ds_write_b16_d16_hi v10, v91 offset:432
    ds_write_b16 v10, v92 offset:576
    ds_write_b16_d16_hi v10, v92 offset:720
    ds_write_b16 v10, v93 offset:864
    ds_write_b16_d16_hi v10, v93 offset:1008
    s_waitcnt vmcnt(0)
    v_lshlrev_b32 v84, 16, v100
    v_and_b32 v85, 0xffff0000, v100
    v_mul_f32 v84, v84, v35
    v_mul_f32 v85, v85, v39
    v_cvt_pk_bf16_f32 v86, v84, v85
    v_lshlrev_b32 v87, 16, v86
    v_and_b32 v88, 0xffff0000, v86
    v_lshlrev_b32 v84, 16, v104
    v_and_b32 v85, 0xffff0000, v104
    v_mul_f32 v84, v84, v34
    v_mul_f32 v85, v85, v38
    v_cvt_pk_bf16_f32 v86, v84, v85
    v_lshlrev_b32 v84, 16, v86
    v_and_b32 v85, 0xffff0000, v86
    v_add_f32 v87, v87, v84
    v_add_f32 v88, v88, v85
    v_cvt_pk_bf16_f32 v86, v87, v88
    v_lshlrev_b32 v87, 16, v86
    v_and_b32 v88, 0xffff0000, v86
    v_lshlrev_b32 v84, 16, v108
    v_and_b32 v85, 0xffff0000, v108
    v_mul_f32 v84, v84, v33
    v_mul_f32 v85, v85, v37
    v_cvt_pk_bf16_f32 v86, v84, v85
    v_lshlrev_b32 v84, 16, v86
    v_and_b32 v85, 0xffff0000, v86
    v_add_f32 v87, v87, v84
    v_add_f32 v88, v88, v85
    v_cvt_pk_bf16_f32 v86, v87, v88
    v_lshlrev_b32 v87, 16, v86
    v_and_b32 v88, 0xffff0000, v86
    v_lshlrev_b32 v84, 16, v112
    v_and_b32 v85, 0xffff0000, v112
    v_mul_f32 v84, v84, v32
    v_mul_f32 v85, v85, v36
    v_cvt_pk_bf16_f32 v86, v84, v85
    v_lshlrev_b32 v84, 16, v86
    v_and_b32 v85, 0xffff0000, v86
    v_add_f32 v87, v87, v84
    v_add_f32 v88, v88, v85
    v_cvt_pk_bf16_f32 v86, v87, v88
    v_lshlrev_b32 v87, 16, v86
    v_and_b32 v88, 0xffff0000, v86
    v_lshlrev_b32 v84, 16, v116
    v_and_b32 v85, 0xffff0000, v116
    v_mul_f32 v87, v87, v84
    v_mul_f32 v88, v88, v85
    v_cvt_pk_bf16_f32 v90, v87, v88
    v_lshlrev_b32 v84, 16, v101
    v_and_b32 v85, 0xffff0000, v101
    v_mul_f32 v84, v84, v43
    v_mul_f32 v85, v85, v47
    v_cvt_pk_bf16_f32 v86, v84, v85
    v_lshlrev_b32 v87, 16, v86
    v_and_b32 v88, 0xffff0000, v86
    v_lshlrev_b32 v84, 16, v105
    v_and_b32 v85, 0xffff0000, v105
    v_mul_f32 v84, v84, v42
    v_mul_f32 v85, v85, v46
    v_cvt_pk_bf16_f32 v86, v84, v85
    v_lshlrev_b32 v84, 16, v86
    v_and_b32 v85, 0xffff0000, v86
    v_add_f32 v87, v87, v84
    v_add_f32 v88, v88, v85
    v_cvt_pk_bf16_f32 v86, v87, v88
    v_lshlrev_b32 v87, 16, v86
    v_and_b32 v88, 0xffff0000, v86
    v_lshlrev_b32 v84, 16, v109
    v_and_b32 v85, 0xffff0000, v109
    v_mul_f32 v84, v84, v41
    v_mul_f32 v85, v85, v45
    v_cvt_pk_bf16_f32 v86, v84, v85
    v_lshlrev_b32 v84, 16, v86
    v_and_b32 v85, 0xffff0000, v86
    v_add_f32 v87, v87, v84
    v_add_f32 v88, v88, v85
    v_cvt_pk_bf16_f32 v86, v87, v88
    v_lshlrev_b32 v87, 16, v86
    v_and_b32 v88, 0xffff0000, v86
    v_lshlrev_b32 v84, 16, v113
    v_and_b32 v85, 0xffff0000, v113
    v_mul_f32 v84, v84, v40
    v_mul_f32 v85, v85, v44
    v_cvt_pk_bf16_f32 v86, v84, v85
    v_lshlrev_b32 v84, 16, v86
    v_and_b32 v85, 0xffff0000, v86
    v_add_f32 v87, v87, v84
    v_add_f32 v88, v88, v85
    v_cvt_pk_bf16_f32 v86, v87, v88
    v_lshlrev_b32 v87, 16, v86
    v_and_b32 v88, 0xffff0000, v86
    v_lshlrev_b32 v84, 16, v117
    v_and_b32 v85, 0xffff0000, v117
    v_mul_f32 v87, v87, v84
    v_mul_f32 v88, v88, v85
    v_cvt_pk_bf16_f32 v91, v87, v88
    v_lshlrev_b32 v84, 16, v102
    v_and_b32 v85, 0xffff0000, v102
    v_mul_f32 v84, v84, v51
    v_mul_f32 v85, v85, v55
    v_cvt_pk_bf16_f32 v86, v84, v85
    v_lshlrev_b32 v87, 16, v86
    v_and_b32 v88, 0xffff0000, v86
    v_lshlrev_b32 v84, 16, v106
    v_and_b32 v85, 0xffff0000, v106
    v_mul_f32 v84, v84, v50
    v_mul_f32 v85, v85, v54
    v_cvt_pk_bf16_f32 v86, v84, v85
    v_lshlrev_b32 v84, 16, v86
    v_and_b32 v85, 0xffff0000, v86
    v_add_f32 v87, v87, v84
    v_add_f32 v88, v88, v85
    v_cvt_pk_bf16_f32 v86, v87, v88
    v_lshlrev_b32 v87, 16, v86
    v_and_b32 v88, 0xffff0000, v86
    v_lshlrev_b32 v84, 16, v110
    v_and_b32 v85, 0xffff0000, v110
    v_mul_f32 v84, v84, v49
    v_mul_f32 v85, v85, v53
    v_cvt_pk_bf16_f32 v86, v84, v85
    v_lshlrev_b32 v84, 16, v86
    v_and_b32 v85, 0xffff0000, v86
    v_add_f32 v87, v87, v84
    v_add_f32 v88, v88, v85
    v_cvt_pk_bf16_f32 v86, v87, v88
    v_lshlrev_b32 v87, 16, v86
    v_and_b32 v88, 0xffff0000, v86
    v_lshlrev_b32 v84, 16, v114
    v_and_b32 v85, 0xffff0000, v114
    v_mul_f32 v84, v84, v48
    v_mul_f32 v85, v85, v52
    v_cvt_pk_bf16_f32 v86, v84, v85
    v_lshlrev_b32 v84, 16, v86
    v_and_b32 v85, 0xffff0000, v86
    v_add_f32 v87, v87, v84
    v_add_f32 v88, v88, v85
    v_cvt_pk_bf16_f32 v86, v87, v88
    v_lshlrev_b32 v87, 16, v86
    v_and_b32 v88, 0xffff0000, v86
    v_lshlrev_b32 v84, 16, v118
    v_and_b32 v85, 0xffff0000, v118
    v_mul_f32 v87, v87, v84
    v_mul_f32 v88, v88, v85
    v_cvt_pk_bf16_f32 v92, v87, v88
    v_lshlrev_b32 v84, 16, v103
    v_and_b32 v85, 0xffff0000, v103
    v_mul_f32 v84, v84, v59
    v_mul_f32 v85, v85, v63
    v_cvt_pk_bf16_f32 v86, v84, v85
    v_lshlrev_b32 v87, 16, v86
    v_and_b32 v88, 0xffff0000, v86
    v_lshlrev_b32 v84, 16, v107
    v_and_b32 v85, 0xffff0000, v107
    v_mul_f32 v84, v84, v58
    v_mul_f32 v85, v85, v62
    v_cvt_pk_bf16_f32 v86, v84, v85
    v_lshlrev_b32 v84, 16, v86
    v_and_b32 v85, 0xffff0000, v86
    v_add_f32 v87, v87, v84
    v_add_f32 v88, v88, v85
    v_cvt_pk_bf16_f32 v86, v87, v88
    v_lshlrev_b32 v87, 16, v86
    v_and_b32 v88, 0xffff0000, v86
    v_lshlrev_b32 v84, 16, v111
    v_and_b32 v85, 0xffff0000, v111
    v_mul_f32 v84, v84, v57
    v_mul_f32 v85, v85, v61
    v_cvt_pk_bf16_f32 v86, v84, v85
    v_lshlrev_b32 v84, 16, v86
    v_and_b32 v85, 0xffff0000, v86
    v_add_f32 v87, v87, v84
    v_add_f32 v88, v88, v85
    v_cvt_pk_bf16_f32 v86, v87, v88
    v_lshlrev_b32 v87, 16, v86
    v_and_b32 v88, 0xffff0000, v86
    v_lshlrev_b32 v84, 16, v115
    v_and_b32 v85, 0xffff0000, v115
    v_mul_f32 v84, v84, v56
    v_mul_f32 v85, v85, v60
    v_cvt_pk_bf16_f32 v86, v84, v85
    v_lshlrev_b32 v84, 16, v86
    v_and_b32 v85, 0xffff0000, v86
    v_add_f32 v87, v87, v84
    v_add_f32 v88, v88, v85
    v_cvt_pk_bf16_f32 v86, v87, v88
    v_lshlrev_b32 v87, 16, v86
    v_and_b32 v88, 0xffff0000, v86
    v_lshlrev_b32 v84, 16, v119
    v_and_b32 v85, 0xffff0000, v119
    v_mul_f32 v87, v87, v84
    v_mul_f32 v88, v88, v85
    v_cvt_pk_bf16_f32 v93, v87, v88
    v_sub_u32 v10, 31, v1
    v_lshl_add_u32 v10, v10, 1, v9
    ds_write_b16 v10, v90 offset:0
    ds_write_b16_d16_hi v10, v90 offset:144
    ds_write_b16 v10, v91 offset:288
    ds_write_b16_d16_hi v10, v91 offset:432
    ds_write_b16 v10, v92 offset:576
    ds_write_b16_d16_hi v10, v92 offset:720
    ds_write_b16 v10, v93 offset:864
    ds_write_b16_d16_hi v10, v93 offset:1008
    s_waitcnt lgkmcnt(0)
    s_barrier
    v_lshrrev_b32 v1, 2, v0
    v_and_b32 v2, 3, v0
    v_mul_u32_u24 v5, 144, v1
    v_lshl_add_u32 v5, v2, 5, v5
    ds_read_b128 v[16:19], v5
    ds_read_b128 v[20:23], v5 offset:16
    v_add_u32 v3, s28, v1
    v_lshlrev_b32 v3, 12, v3
    v_lshl_add_u32 v3, v2, 5, v3
    s_sub_u32 s29, 1984, s3
    s_lshl_b32 s29, s29, 1
    v_add_u32 v3, s29, v3
    s_waitcnt lgkmcnt(0)
    buffer_store_dwordx4 v[16:19], v3, s[20:23], 0 offen
    buffer_store_dwordx4 v[20:23], v3, s[20:23], 0 offen offset:16
    s_endpgm
L_prep_gate:
    s_cmp_ge_u32 s2, 384
    s_cbranch_scc1 L_prep_w1
    s_load_dwordx2 s[4:5], s[0:1], 0
    s_load_dwordx2 s[24:25], s[0:1], 80
    s_sub_u32 s3, s2, 256
    s_lshl_b32 s3, s3, 4
    v_lshrrev_b32 v1, 6, v0
    v_and_b32 v2, 63, v0
    v_lshlrev_b32 v3, 2, v1
    v_add_u32 v3, s3, v3
    v_lshlrev_b32 v4, 10, v3
    v_lshl_add_u32 v4, v2, 4, v4
    v_lshlrev_b32 v5, 4, v2
    s_waitcnt lgkmcnt(0)
    s_mov_b32 s8, s4
    s_mov_b32 s9, s5
    s_mov_b32 s10, 0x200000
    s_mov_b32 s11, 0x00020000
    s_mov_b32 s12, s24
    s_mov_b32 s13, s25
    s_mov_b32 s14, 0x400
    s_mov_b32 s15, 0x00020000
    s_add_u32 s20, s6, 0xe00000
    s_addc_u32 s21, s7, 0
    s_mov_b32 s22, 0x2000
    s_mov_b32 s23, 0x00020000
    buffer_load_dwordx4 v[12:15], v5, s[12:15], 0 offen
    buffer_load_dwordx4 v[24:27], v4, s[8:11], 0 offen offset:0
    buffer_load_dwordx4 v[28:31], v4, s[8:11], 0 offen offset:1024
    buffer_load_dwordx4 v[32:35], v4, s[8:11], 0 offen offset:2048
    buffer_load_dwordx4 v[36:39], v4, s[8:11], 0 offen offset:3072
    v_lshlrev_b32 v3, 2, v3
    v_cmp_eq_u32 vcc, 0, v2
    s_waitcnt vmcnt(3)
    v_lshlrev_b32 v16, 16, v24
    v_and_b32 v17, 0xffff0000, v24
    v_lshlrev_b32 v18, 16, v12
    v_and_b32 v19, 0xffff0000, v12
    v_mul_f32 v16, v16, v18
    v_mul_f32 v17, v17, v19
    v_cvt_pk_bf16_f32 v16, v16, v17
    v_lshlrev_b32 v17, 16, v16
    v_and_b32 v16, 0xffff0000, v16
    v_add_f32 v20, v16, v17
    v_lshlrev_b32 v16, 16, v25
    v_and_b32 v17, 0xffff0000, v25
    v_lshlrev_b32 v18, 16, v13
    v_and_b32 v19, 0xffff0000, v13
    v_mul_f32 v16, v16, v18
    v_mul_f32 v17, v17, v19
    v_cvt_pk_bf16_f32 v16, v16, v17
    v_lshlrev_b32 v17, 16, v16
    v_and_b32 v16, 0xffff0000, v16
    v_add_f32 v20, v20, v17
    v_add_f32 v20, v20, v16
    v_lshlrev_b32 v16, 16, v26
    v_and_b32 v17, 0xffff0000, v26
    v_lshlrev_b32 v18, 16, v14
    v_and_b32 v19, 0xffff0000, v14
    v_mul_f32 v16, v16, v18
    v_mul_f32 v17, v17, v19
    v_cvt_pk_bf16_f32 v16, v16, v17
    v_lshlrev_b32 v17, 16, v16
    v_and_b32 v16, 0xffff0000, v16
    v_add_f32 v20, v20, v17
    v_add_f32 v20, v20, v16
    v_lshlrev_b32 v16, 16, v27
    v_and_b32 v17, 0xffff0000, v27
    v_lshlrev_b32 v18, 16, v15
    v_and_b32 v19, 0xffff0000, v15
    v_mul_f32 v16, v16, v18
    v_mul_f32 v17, v17, v19
    v_cvt_pk_bf16_f32 v16, v16, v17
    v_lshlrev_b32 v17, 16, v16
    v_and_b32 v16, 0xffff0000, v16
    v_add_f32 v20, v20, v17
    v_add_f32 v20, v20, v16
    s_nop 1
    v_add_f32_dpp v20, v20, v20 quad_perm:[1,0,3,2] row_mask:0xf bank_mask:0xf
    s_nop 1
    v_add_f32_dpp v20, v20, v20 quad_perm:[2,3,0,1] row_mask:0xf bank_mask:0xf
    s_nop 1
    v_add_f32_dpp v20, v20, v20 row_half_mirror row_mask:0xf bank_mask:0xf
    s_nop 1
    v_add_f32_dpp v20, v20, v20 row_mirror row_mask:0xf bank_mask:0xf
    s_nop 1
    v_readlane_b32 s30, v20, 0
    v_readlane_b32 s31, v20, 16
    v_readlane_b32 s32, v20, 32
    v_readlane_b32 s33, v20, 48
    s_nop 3
    v_mov_b32 v21, s30
    v_add_f32 v21, s31, v21
    v_add_f32 v21, s32, v21
    v_add_f32 v21, s33, v21
    v_cvt_pk_bf16_f32 v21, v21, v21
    v_lshlrev_b32 v21, 16, v21
    v_mul_f32 v21, 0xbfb8aa3b, v21
    v_exp_f32 v21, v21
    s_nop 0
    v_add_f32 v21, 1.0, v21
    v_rcp_f32 v21, v21
    s_nop 0
    v_cvt_pk_bf16_f32 v21, v21, v21
    v_lshlrev_b32 v40, 16, v21
    s_waitcnt vmcnt(2)
    v_lshlrev_b32 v16, 16, v28
    v_and_b32 v17, 0xffff0000, v28
    v_lshlrev_b32 v18, 16, v12
    v_and_b32 v19, 0xffff0000, v12
    v_mul_f32 v16, v16, v18
    v_mul_f32 v17, v17, v19
    v_cvt_pk_bf16_f32 v16, v16, v17
    v_lshlrev_b32 v17, 16, v16
    v_and_b32 v16, 0xffff0000, v16
    v_add_f32 v20, v16, v17
    v_lshlrev_b32 v16, 16, v29
    v_and_b32 v17, 0xffff0000, v29
    v_lshlrev_b32 v18, 16, v13
    v_and_b32 v19, 0xffff0000, v13
    v_mul_f32 v16, v16, v18
    v_mul_f32 v17, v17, v19
    v_cvt_pk_bf16_f32 v16, v16, v17
    v_lshlrev_b32 v17, 16, v16
    v_and_b32 v16, 0xffff0000, v16
    v_add_f32 v20, v20, v17
    v_add_f32 v20, v20, v16
    v_lshlrev_b32 v16, 16, v30
    v_and_b32 v17, 0xffff0000, v30
    v_lshlrev_b32 v18, 16, v14
    v_and_b32 v19, 0xffff0000, v14
    v_mul_f32 v16, v16, v18
    v_mul_f32 v17, v17, v19
    v_cvt_pk_bf16_f32 v16, v16, v17
    v_lshlrev_b32 v17, 16, v16
    v_and_b32 v16, 0xffff0000, v16
    v_add_f32 v20, v20, v17
    v_add_f32 v20, v20, v16
    v_lshlrev_b32 v16, 16, v31
    v_and_b32 v17, 0xffff0000, v31
    v_lshlrev_b32 v18, 16, v15
    v_and_b32 v19, 0xffff0000, v15
    v_mul_f32 v16, v16, v18
    v_mul_f32 v17, v17, v19
    v_cvt_pk_bf16_f32 v16, v16, v17
    v_lshlrev_b32 v17, 16, v16
    v_and_b32 v16, 0xffff0000, v16
    v_add_f32 v20, v20, v17
    v_add_f32 v20, v20, v16
    s_nop 1
    v_add_f32_dpp v20, v20, v20 quad_perm:[1,0,3,2] row_mask:0xf bank_mask:0xf
    s_nop 1
    v_add_f32_dpp v20, v20, v20 quad_perm:[2,3,0,1] row_mask:0xf bank_mask:0xf
    s_nop 1
    v_add_f32_dpp v20, v20, v20 row_half_mirror row_mask:0xf bank_mask:0xf
    s_nop 1
    v_add_f32_dpp v20, v20, v20 row_mirror row_mask:0xf bank_mask:0xf
    s_nop 1
    v_readlane_b32 s30, v20, 0
    v_readlane_b32 s31, v20, 16
    v_readlane_b32 s32, v20, 32
    v_readlane_b32 s33, v20, 48
    s_nop 3
    v_mov_b32 v21, s30
    v_add_f32 v21, s31, v21
    v_add_f32 v21, s32, v21
    v_add_f32 v21, s33, v21
    v_cvt_pk_bf16_f32 v21, v21, v21
    v_lshlrev_b32 v21, 16, v21
    v_mul_f32 v21, 0xbfb8aa3b, v21
    v_exp_f32 v21, v21
    s_nop 0
    v_add_f32 v21, 1.0, v21
    v_rcp_f32 v21, v21
    s_nop 0
    v_cvt_pk_bf16_f32 v21, v21, v21
    v_lshlrev_b32 v41, 16, v21
    s_waitcnt vmcnt(1)
    v_lshlrev_b32 v16, 16, v32
    v_and_b32 v17, 0xffff0000, v32
    v_lshlrev_b32 v18, 16, v12
    v_and_b32 v19, 0xffff0000, v12
    v_mul_f32 v16, v16, v18
    v_mul_f32 v17, v17, v19
    v_cvt_pk_bf16_f32 v16, v16, v17
    v_lshlrev_b32 v17, 16, v16
    v_and_b32 v16, 0xffff0000, v16
    v_add_f32 v20, v16, v17
    v_lshlrev_b32 v16, 16, v33
    v_and_b32 v17, 0xffff0000, v33
    v_lshlrev_b32 v18, 16, v13
    v_and_b32 v19, 0xffff0000, v13
    v_mul_f32 v16, v16, v18
    v_mul_f32 v17, v17, v19
    v_cvt_pk_bf16_f32 v16, v16, v17
    v_lshlrev_b32 v17, 16, v16
    v_and_b32 v16, 0xffff0000, v16
    v_add_f32 v20, v20, v17
    v_add_f32 v20, v20, v16
    v_lshlrev_b32 v16, 16, v34
    v_and_b32 v17, 0xffff0000, v34
    v_lshlrev_b32 v18, 16, v14
    v_and_b32 v19, 0xffff0000, v14
    v_mul_f32 v16, v16, v18
    v_mul_f32 v17, v17, v19
    v_cvt_pk_bf16_f32 v16, v16, v17
    v_lshlrev_b32 v17, 16, v16
    v_and_b32 v16, 0xffff0000, v16
    v_add_f32 v20, v20, v17
    v_add_f32 v20, v20, v16
    v_lshlrev_b32 v16, 16, v35
    v_and_b32 v17, 0xffff0000, v35
    v_lshlrev_b32 v18, 16, v15
    v_and_b32 v19, 0xffff0000, v15
    v_mul_f32 v16, v16, v18
    v_mul_f32 v17, v17, v19
    v_cvt_pk_bf16_f32 v16, v16, v17
    v_lshlrev_b32 v17, 16, v16
    v_and_b32 v16, 0xffff0000, v16
    v_add_f32 v20, v20, v17
    v_add_f32 v20, v20, v16
    s_nop 1
    v_add_f32_dpp v20, v20, v20 quad_perm:[1,0,3,2] row_mask:0xf bank_mask:0xf
    s_nop 1
    v_add_f32_dpp v20, v20, v20 quad_perm:[2,3,0,1] row_mask:0xf bank_mask:0xf
    s_nop 1
    v_add_f32_dpp v20, v20, v20 row_half_mirror row_mask:0xf bank_mask:0xf
    s_nop 1
    v_add_f32_dpp v20, v20, v20 row_mirror row_mask:0xf bank_mask:0xf
    s_nop 1
    v_readlane_b32 s30, v20, 0
    v_readlane_b32 s31, v20, 16
    v_readlane_b32 s32, v20, 32
    v_readlane_b32 s33, v20, 48
    s_nop 3
    v_mov_b32 v21, s30
    v_add_f32 v21, s31, v21
    v_add_f32 v21, s32, v21
    v_add_f32 v21, s33, v21
    v_cvt_pk_bf16_f32 v21, v21, v21
    v_lshlrev_b32 v21, 16, v21
    v_mul_f32 v21, 0xbfb8aa3b, v21
    v_exp_f32 v21, v21
    s_nop 0
    v_add_f32 v21, 1.0, v21
    v_rcp_f32 v21, v21
    s_nop 0
    v_cvt_pk_bf16_f32 v21, v21, v21
    v_lshlrev_b32 v42, 16, v21
    s_waitcnt vmcnt(0)
    v_lshlrev_b32 v16, 16, v36
    v_and_b32 v17, 0xffff0000, v36
    v_lshlrev_b32 v18, 16, v12
    v_and_b32 v19, 0xffff0000, v12
    v_mul_f32 v16, v16, v18
    v_mul_f32 v17, v17, v19
    v_cvt_pk_bf16_f32 v16, v16, v17
    v_lshlrev_b32 v17, 16, v16
    v_and_b32 v16, 0xffff0000, v16
    v_add_f32 v20, v16, v17
    v_lshlrev_b32 v16, 16, v37
    v_and_b32 v17, 0xffff0000, v37
    v_lshlrev_b32 v18, 16, v13
    v_and_b32 v19, 0xffff0000, v13
    v_mul_f32 v16, v16, v18
    v_mul_f32 v17, v17, v19
    v_cvt_pk_bf16_f32 v16, v16, v17
    v_lshlrev_b32 v17, 16, v16
    v_and_b32 v16, 0xffff0000, v16
    v_add_f32 v20, v20, v17
    v_add_f32 v20, v20, v16
    v_lshlrev_b32 v16, 16, v38
    v_and_b32 v17, 0xffff0000, v38
    v_lshlrev_b32 v18, 16, v14
    v_and_b32 v19, 0xffff0000, v14
    v_mul_f32 v16, v16, v18
    v_mul_f32 v17, v17, v19
    v_cvt_pk_bf16_f32 v16, v16, v17
    v_lshlrev_b32 v17, 16, v16
    v_and_b32 v16, 0xffff0000, v16
    v_add_f32 v20, v20, v17
    v_add_f32 v20, v20, v16
    v_lshlrev_b32 v16, 16, v39
    v_and_b32 v17, 0xffff0000, v39
    v_lshlrev_b32 v18, 16, v15
    v_and_b32 v19, 0xffff0000, v15
    v_mul_f32 v16, v16, v18
    v_mul_f32 v17, v17, v19
    v_cvt_pk_bf16_f32 v16, v16, v17
    v_lshlrev_b32 v17, 16, v16
    v_and_b32 v16, 0xffff0000, v16
    v_add_f32 v20, v20, v17
    v_add_f32 v20, v20, v16
    s_nop 1
    v_add_f32_dpp v20, v20, v20 quad_perm:[1,0,3,2] row_mask:0xf bank_mask:0xf
    s_nop 1
    v_add_f32_dpp v20, v20, v20 quad_perm:[2,3,0,1] row_mask:0xf bank_mask:0xf
    s_nop 1
    v_add_f32_dpp v20, v20, v20 row_half_mirror row_mask:0xf bank_mask:0xf
    s_nop 1
    v_add_f32_dpp v20, v20, v20 row_mirror row_mask:0xf bank_mask:0xf
    s_nop 1
    v_readlane_b32 s30, v20, 0
    v_readlane_b32 s31, v20, 16
    v_readlane_b32 s32, v20, 32
    v_readlane_b32 s33, v20, 48
    s_nop 3
    v_mov_b32 v21, s30
    v_add_f32 v21, s31, v21
    v_add_f32 v21, s32, v21
    v_add_f32 v21, s33, v21
    v_cvt_pk_bf16_f32 v21, v21, v21
    v_lshlrev_b32 v21, 16, v21
    v_mul_f32 v21, 0xbfb8aa3b, v21
    v_exp_f32 v21, v21
    s_nop 0
    v_add_f32 v21, 1.0, v21
    v_rcp_f32 v21, v21
    s_nop 0
    v_cvt_pk_bf16_f32 v21, v21, v21
    v_lshlrev_b32 v43, 16, v21
    s_and_saveexec_b64 s[34:35], vcc
    buffer_store_dword v40, v3, s[20:23], 0 offen offset:0
    buffer_store_dword v41, v3, s[20:23], 0 offen offset:4
    buffer_store_dword v42, v3, s[20:23], 0 offen offset:8
    buffer_store_dword v43, v3, s[20:23], 0 offen offset:12
    s_endpgm
L_prep_w1:
    s_cmp_ge_u32 s2, 728
    s_cbranch_scc1 L_prep_w2
    s_load_dwordx2 s[4:5], s[0:1], 56
    s_sub_u32 s3, s2, 384
    s_and_b32 s28, s3, 7
    s_lshl_b32 s28, s28, 6
    s_lshr_b32 s29, s3, 3
    s_lshl_b32 s30, s29, 5
    s_waitcnt lgkmcnt(0)
    s_mov_b32 s8, s4
    s_mov_b32 s9, s5
    s_mov_b32 s10, 0x158000
    s_mov_b32 s11, 0x00020000
    s_add_u32 s20, s6, 0x200000
    s_addc_u32 s21, s7, 0
    s_mov_b32 s22, 0x158000
    s_mov_b32 s23, 0x00020000
    v_lshrrev_b32 v1, 2, v0
    v_and_b32 v2, 3, v0
    v_add_u32 v3, s28, v1
    s_mov_b32 s40, 2752
    v_mul_lo_u32 v3, v3, s40
    v_lshlrev_b32 v4, 4, v2
    s_lshl_b32 s41, s30, 1
    v_add3_u32 v3, v3, v4, s41
    buffer_load_dwordx4 v[8:11], v3, s[8:11], 0 offen
    v_mul_u32_u24 v5, 1152, v2
    v_lshl_add_u32 v5, v1, 1, v5
    s_waitcnt vmcnt(0)
    ds_write_b16 v5, v8 offset:0
    ds_write_b16_d16_hi v5, v8 offset:144
    ds_write_b16 v5, v9 offset:288
    ds_write_b16_d16_hi v5, v9 offset:432
    ds_write_b16 v5, v10 offset:576
    ds_write_b16_d16_hi v5, v10 offset:720
    ds_write_b16 v5, v11 offset:864
    ds_write_b16_d16_hi v5, v11 offset:1008
    s_waitcnt lgkmcnt(0)
    s_barrier
    v_lshrrev_b32 v1, 3, v0
    v_and_b32 v2, 7, v0
    v_mul_u32_u24 v5, 144, v1
    v_lshl_add_u32 v5, v2, 4, v5
    ds_read_b128 v[8:11], v5
    v_add_u32 v3, s30, v1
    s_mov_b32 s40, 1024
    v_mul_lo_u32 v3, v3, s40
    v_lshlrev_b32 v4, 4, v2
    s_lshl_b32 s41, s28, 1
    v_add3_u32 v3, v3, v4, s41
    s_waitcnt lgkmcnt(0)
    buffer_store_dwordx4 v[8:11], v3, s[20:23], 0 offen
    s_endpgm
L_prep_w2:
    s_load_dwordx2 s[4:5], s[0:1], 72
    s_sub_u32 s3, s2, 728
    s_and_b32 s28, s3, 7
    s_lshl_b32 s28, s28, 6
    s_lshr_b32 s29, s3, 3
    s_lshl_b32 s30, s29, 5
    s_waitcnt lgkmcnt(0)
    s_mov_b32 s8, s4
    s_mov_b32 s9, s5
    s_mov_b32 s10, 0x158000
    s_mov_b32 s11, 0x00020000
    s_add_u32 s20, s6, 0x400000
    s_addc_u32 s21, s7, 0
    s_mov_b32 s22, 0x160000
    s_mov_b32 s23, 0x00020000
    v_lshrrev_b32 v1, 3, v0
    v_and_b32 v2, 7, v0
    v_add_u32 v3, s30, v1
    s_mov_b32 s40, 1024
    v_mul_lo_u32 v3, v3, s40
    v_lshlrev_b32 v4, 4, v2
    s_lshl_b32 s41, s28, 1
    v_add3_u32 v3, v3, v4, s41
    buffer_load_dwordx4 v[8:11], v3, s[8:11], 0 offen
    v_mul_u32_u24 v5, 640, v2
    v_lshl_add_u32 v5, v1, 1, v5
    s_waitcnt vmcnt(0)
    ds_write_b16 v5, v8 offset:0
    ds_write_b16_d16_hi v5, v8 offset:80
    ds_write_b16 v5, v9 offset:160
    ds_write_b16_d16_hi v5, v9 offset:240
    ds_write_b16 v5, v10 offset:320
    ds_write_b16_d16_hi v5, v10 offset:400
    ds_write_b16 v5, v11 offset:480
    ds_write_b16_d16_hi v5, v11 offset:560
    s_waitcnt lgkmcnt(0)
    s_barrier
    v_lshrrev_b32 v1, 2, v0
    v_and_b32 v2, 3, v0
    v_mul_u32_u24 v5, 80, v1
    v_lshl_add_u32 v5, v2, 4, v5
    ds_read_b128 v[8:11], v5
    v_add_u32 v3, s28, v1
    s_mov_b32 s40, 2816
    v_mul_lo_u32 v3, v3, s40
    v_lshlrev_b32 v4, 4, v2
    s_lshl_b32 s41, s30, 1
    v_add3_u32 v3, v3, v4, s41
    s_waitcnt lgkmcnt(0)
    buffer_store_dwordx4 v[8:11], v3, s[20:23], 0 offen
    s_endpgm
L_prep_exit:
    s_endpgm
.globl mid_kernel
.p2align 8
.type mid_kernel,@function
mid_kernel:
    s_cmp_ge_u32 s2, 496
    s_cbranch_scc1 L_mid_exit
    s_cmp_ge_u32 s2, 256
    s_cbranch_scc1 L_mid_g1
    s_load_dwordx2 s[4:5], s[0:1], 32
    s_load_dwordx2 s[6:7], s[0:1], 104
    s_load_dwordx2 s[24:25], s[0:1], 40
    v_lshrrev_b32 v1, 6, v0
    v_and_b32 v2, 63, v0
    v_readfirstlane_b32 s36, v1
    s_lshr_b32 s37, s36, 1
    s_and_b32 s38, s36, 1
    s_lshl_b32 s39, s2, 1
    s_add_u32 s40, s39, s37
    v_and_b32 v3, 31, v2
    v_lshrrev_b32 v4, 5, v2
    s_waitcnt lgkmcnt(0)
    s_mov_b32 s8, s4
    s_mov_b32 s9, s5
    s_mov_b32 s10, 0x200000
    s_mov_b32 s11, 0x00020000
    s_mov_b32 s12, s6
    s_mov_b32 s13, s7
    s_mov_b32 s14, 0x200000
    s_mov_b32 s15, 0x00020000
    s_add_u32 s16, s6, 0xc00000
    s_addc_u32 s17, s7, 0
    s_mov_b32 s18, 0x200000
    s_mov_b32 s19, 0x00020000
    s_mov_b32 s20, s24
    s_mov_b32 s21, s25
    s_mov_b32 s22, 0x400
    s_mov_b32 s23, 0x00020000
    s_lshl_b32 s41, s39, 12
    v_lshlrev_b32 v5, 4, v0
    v_add_u32 v6, s41, v5
    v_add_u32 v8, 0x1000, v6
    buffer_load_dwordx4 v[16:19], v6, s[8:11], 0 offen
    buffer_load_dwordx4 v[20:23], v6, s[8:11], 0 offen offset:16
    buffer_load_dwordx4 v[24:27], v8, s[8:11], 0 offen
    buffer_load_dwordx4 v[28:31], v8, s[8:11], 0 offen offset:16
    v_and_b32 v32, 7, v0
    v_lshrrev_b32 v33, 3, v0
    v_lshlrev_b32 v34, 12, v33
    v_add_u32 v34, s41, v34
    s_lshl_b32 s42, s40, 12
    s_lshl_b32 s43, s38, 6
    s_sub_u32 s42, s42, s43
    s_add_u32 s42, s42, 4064
    v_lshlrev_b32 v7, 7, v3
    v_sub_u32 v7, s42, v7
    v_lshl_add_u32 v7, v4, 4, v7
    buffer_load_dwordx4 v[96:99], v7, s[12:15], 0 offen
    v_subrev_u32 v8, 32, v7
    buffer_load_dwordx4 v[100:103], v8, s[12:15], 0 offen
    s_lshl_b32 s44, s40, 1
    v_mov_b32 v9, s44
    buffer_load_ushort v10, v9, s[20:23], 0 offen
    v_mov_b32 v64, 0
    v_mov_b32 v65, 0
    v_mov_b32 v66, 0
    v_mov_b32 v67, 0
    v_mov_b32 v68, 0
    v_mov_b32 v69, 0
    v_mov_b32 v70, 0
    v_mov_b32 v71, 0
    v_mov_b32 v72, 0
    v_mov_b32 v73, 0
    v_mov_b32 v74, 0
    v_mov_b32 v75, 0
    v_mov_b32 v76, 0
    v_mov_b32 v77, 0
    v_mov_b32 v78, 0
    v_mov_b32 v79, 0
    v_mov_b32 v80, 0
    v_mov_b32 v81, 0
    v_mov_b32 v82, 0
    v_mov_b32 v83, 0
    v_mov_b32 v84, 0
    v_mov_b32 v85, 0
    v_mov_b32 v86, 0
    v_mov_b32 v87, 0
    v_mov_b32 v88, 0
    v_mov_b32 v89, 0
    v_mov_b32 v90, 0
    v_mov_b32 v91, 0
    v_mov_b32 v92, 0
    v_mov_b32 v93, 0
    v_mov_b32 v94, 0
    v_mov_b32 v95, 0
    v_mov_b32 v136, -1
    v_cmp_ne_u32 vcc, 32, v2
    s_nop 1
    v_cndmask_b32 v136, 0, v136, vcc
    s_waitcnt vmcnt(4)
    ds_write_b128 v5, v[16:19] offset:128

    v_alignbyte_b32 v40, v17, v16, 2
    v_alignbyte_b32 v44, v18, v17, 2
    v_alignbyte_b32 v41, v18, v17, 2
    v_alignbyte_b32 v45, v19, v18, 2
    v_alignbyte_b32 v42, v19, v18, 2
    v_alignbyte_b32 v46, v20, v19, 2
    v_alignbyte_b32 v43, v20, v19, 2
    v_alignbyte_b32 v47, v21, v20, 2
    ds_write_b128 v5, v[40:43] offset:4544
    ds_write_b128 v5, v[44:47] offset:13376
    v_mov_b32 v48, v17
    v_mov_b32 v49, v18
    v_mov_b32 v50, v19
    v_mov_b32 v51, v20
    ds_write_b128 v5, v[48:51] offset:8960
    s_waitcnt vmcnt(2)
    ds_write_b128 v5, v[24:27] offset:17792

    v_alignbyte_b32 v40, v25, v24, 2
    v_alignbyte_b32 v44, v26, v25, 2
    v_alignbyte_b32 v41, v26, v25, 2
    v_alignbyte_b32 v45, v27, v26, 2
    v_alignbyte_b32 v42, v27, v26, 2
    v_alignbyte_b32 v46, v28, v27, 2
    v_alignbyte_b32 v43, v28, v27, 2
    v_alignbyte_b32 v47, v29, v28, 2
    ds_write_b128 v5, v[40:43] offset:22208
    ds_write_b128 v5, v[44:47] offset:31040
    v_mov_b32 v48, v25
    v_mov_b32 v49, v26
    v_mov_b32 v50, v27
    v_mov_b32 v51, v28
    ds_write_b128 v5, v[48:51] offset:26624
    v_cmp_gt_u32 vcc, 16, v0
    s_and_saveexec_b64 s[34:35], vcc
    s_cbranch_execz L_conv_nozero
    buffer_load_dwordx4 v[20:23], v34, s[8:11], 0 offen
    v_mov_b32 v16, 0
    v_mov_b32 v17, 0
    v_mov_b32 v18, 0
    v_mov_b32 v19, 0
    v_mul_u32_u24 v36, 17664, v33
    v_lshl_add_u32 v36, v32, 4, v36
    v_mov_b32 v37, v5
    v_mov_b32 v5, v36
    v_cmp_eq_u32 vcc, 7, v32
    s_waitcnt vmcnt(0)
    v_cndmask_b32 v20, 0, v20, vcc
    v_cndmask_b32 v21, 0, v21, vcc
    v_cndmask_b32 v22, 0, v22, vcc
    v_cndmask_b32 v23, 0, v23, vcc
    ds_write_b128 v5, v[16:19] offset:0

    v_alignbyte_b32 v40, v17, v16, 2
    v_alignbyte_b32 v44, v18, v17, 2
    v_alignbyte_b32 v41, v18, v17, 2
    v_alignbyte_b32 v45, v19, v18, 2
    v_alignbyte_b32 v42, v19, v18, 2
    v_alignbyte_b32 v46, v20, v19, 2
    v_alignbyte_b32 v43, v20, v19, 2
    v_alignbyte_b32 v47, v21, v20, 2
    ds_write_b128 v5, v[40:43] offset:4416
    ds_write_b128 v5, v[44:47] offset:13248
    v_mov_b32 v48, v17
    v_mov_b32 v49, v18
    v_mov_b32 v50, v19
    v_mov_b32 v51, v20
    ds_write_b128 v5, v[48:51] offset:8832
    v_mov_b32 v5, v37
L_conv_nozero:
    s_mov_b64 exec, s[34:35]
    v_add_u32 v11, 1, v3
    v_and_b32 v11, 3, v11
    v_mul_u32_u24 v12, 4416, v11
    v_lshl_add_u32 v13, v4, 3, v3
    v_add_u32 v13, 49, v13
    v_sub_u32 v13, v13, v11
    v_lshl_add_u32 v12, v13, 1, v12
    s_mul_i32 s45, s37, 17664
    s_sub_u32 s45, s45, s43
    s_sub_u32 s45, s45, 32
    v_add_u32 v11, s45, v12
    s_waitcnt lgkmcnt(0)
    s_barrier
    ds_read_b64 v[104:105], v11 offset:32
    ds_read_b64 v[106:107], v11 offset:40
    ds_read_b64 v[108:109], v11 offset:96
    ds_read_b64 v[110:111], v11 offset:104
    ds_read_b64 v[112:113], v11 offset:0
    ds_read_b64 v[114:115], v11 offset:8
    ds_read_b64 v[116:117], v11 offset:64
    ds_read_b64 v[118:119], v11 offset:72
    s_waitcnt vmcnt(0)
    ds_read_b64 v[120:121], v11 offset:160
    ds_read_b64 v[122:123], v11 offset:168
    ds_read_b64 v[124:125], v11 offset:224
    ds_read_b64 v[126:127], v11 offset:232
    ds_read_b64 v[128:129], v11 offset:128
    ds_read_b64 v[130:131], v11 offset:136
    ds_read_b64 v[132:133], v11 offset:192
    ds_read_b64 v[134:135], v11 offset:200
    s_waitcnt lgkmcnt(8)
    v_mfma_f32_32x32x16_bf16 v[64:79], v[104:107], v[96:99], v[64:79]
    v_mfma_f32_32x32x16_bf16 v[80:95], v[108:111], v[96:99], v[80:95]
    v_mfma_f32_32x32x16_bf16 v[64:79], v[112:115], v[100:103], v[64:79]
    v_mfma_f32_32x32x16_bf16 v[80:95], v[116:119], v[100:103], v[80:95]
    v_and_b32_dpp v96, v96, v136 wave_shr:1 row_mask:0xf bank_mask:0xf bound_ctrl:0
    v_and_b32_dpp v97, v97, v136 wave_shr:1 row_mask:0xf bank_mask:0xf bound_ctrl:0
    v_and_b32_dpp v98, v98, v136 wave_shr:1 row_mask:0xf bank_mask:0xf bound_ctrl:0
    v_and_b32_dpp v99, v99, v136 wave_shr:1 row_mask:0xf bank_mask:0xf bound_ctrl:0
    v_and_b32_dpp v100, v100, v136 wave_shr:1 row_mask:0xf bank_mask:0xf bound_ctrl:0
    v_and_b32_dpp v101, v101, v136 wave_shr:1 row_mask:0xf bank_mask:0xf bound_ctrl:0
    v_and_b32_dpp v102, v102, v136 wave_shr:1 row_mask:0xf bank_mask:0xf bound_ctrl:0
    v_and_b32_dpp v103, v103, v136 wave_shr:1 row_mask:0xf bank_mask:0xf bound_ctrl:0
    ds_read_b64 v[104:105], v11 offset:288
    ds_read_b64 v[106:107], v11 offset:296
    ds_read_b64 v[108:109], v11 offset:352
    ds_read_b64 v[110:111], v11 offset:360
    ds_read_b64 v[112:113], v11 offset:256
    ds_read_b64 v[114:115], v11 offset:264
    ds_read_b64 v[116:117], v11 offset:320
    ds_read_b64 v[118:119], v11 offset:328
    s_waitcnt lgkmcnt(8)
    v_mfma_f32_32x32x16_bf16 v[64:79], v[120:123], v[96:99], v[64:79]
    v_mfma_f32_32x32x16_bf16 v[80:95], v[124:127], v[96:99], v[80:95]
    v_mfma_f32_32x32x16_bf16 v[64:79], v[128:131], v[100:103], v[64:79]
    v_mfma_f32_32x32x16_bf16 v[80:95], v[132:135], v[100:103], v[80:95]
    v_and_b32_dpp v96, v96, v136 wave_shr:1 row_mask:0xf bank_mask:0xf bound_ctrl:0
    v_and_b32_dpp v97, v97, v136 wave_shr:1 row_mask:0xf bank_mask:0xf bound_ctrl:0
    v_and_b32_dpp v98, v98, v136 wave_shr:1 row_mask:0xf bank_mask:0xf bound_ctrl:0
    v_and_b32_dpp v99, v99, v136 wave_shr:1 row_mask:0xf bank_mask:0xf bound_ctrl:0
    v_and_b32_dpp v100, v100, v136 wave_shr:1 row_mask:0xf bank_mask:0xf bound_ctrl:0
    v_and_b32_dpp v101, v101, v136 wave_shr:1 row_mask:0xf bank_mask:0xf bound_ctrl:0
    v_and_b32_dpp v102, v102, v136 wave_shr:1 row_mask:0xf bank_mask:0xf bound_ctrl:0
    v_and_b32_dpp v103, v103, v136 wave_shr:1 row_mask:0xf bank_mask:0xf bound_ctrl:0
    ds_read_b64 v[120:121], v11 offset:416
    ds_read_b64 v[122:123], v11 offset:424
    ds_read_b64 v[124:125], v11 offset:480
    ds_read_b64 v[126:127], v11 offset:488
    ds_read_b64 v[128:129], v11 offset:384
    ds_read_b64 v[130:131], v11 offset:392
    ds_read_b64 v[132:133], v11 offset:448
    ds_read_b64 v[134:135], v11 offset:456
    s_waitcnt lgkmcnt(8)
    v_mfma_f32_32x32x16_bf16 v[64:79], v[104:107], v[96:99], v[64:79]
    v_mfma_f32_32x32x16_bf16 v[80:95], v[108:111], v[96:99], v[80:95]
    v_mfma_f32_32x32x16_bf16 v[64:79], v[112:115], v[100:103], v[64:79]
    v_mfma_f32_32x32x16_bf16 v[80:95], v[116:119], v[100:103], v[80:95]
    v_and_b32_dpp v96, v96, v136 wave_shr:1 row_mask:0xf bank_mask:0xf bound_ctrl:0
    v_and_b32_dpp v97, v97, v136 wave_shr:1 row_mask:0xf bank_mask:0xf bound_ctrl:0
    v_and_b32_dpp v98, v98, v136 wave_shr:1 row_mask:0xf bank_mask:0xf bound_ctrl:0
    v_and_b32_dpp v99, v99, v136 wave_shr:1 row_mask:0xf bank_mask:0xf bound_ctrl:0
    v_and_b32_dpp v100, v100, v136 wave_shr:1 row_mask:0xf bank_mask:0xf bound_ctrl:0
    v_and_b32_dpp v101, v101, v136 wave_shr:1 row_mask:0xf bank_mask:0xf bound_ctrl:0
    v_and_b32_dpp v102, v102, v136 wave_shr:1 row_mask:0xf bank_mask:0xf bound_ctrl:0
    v_and_b32_dpp v103, v103, v136 wave_shr:1 row_mask:0xf bank_mask:0xf bound_ctrl:0
    ds_read_b64 v[104:105], v11 offset:544
    ds_read_b64 v[106:107], v11 offset:552
    ds_read_b64 v[108:109], v11 offset:608
    ds_read_b64 v[110:111], v11 offset:616
    ds_read_b64 v[112:113], v11 offset:512
    ds_read_b64 v[114:115], v11 offset:520
    ds_read_b64 v[116:117], v11 offset:576
    ds_read_b64 v[118:119], v11 offset:584
    s_waitcnt lgkmcnt(8)
    v_mfma_f32_32x32x16_bf16 v[64:79], v[120:123], v[96:99], v[64:79]
    v_mfma_f32_32x32x16_bf16 v[80:95], v[124:127], v[96:99], v[80:95]
    v_mfma_f32_32x32x16_bf16 v[64:79], v[128:131], v[100:103], v[64:79]
    v_mfma_f32_32x32x16_bf16 v[80:95], v[132:135], v[100:103], v[80:95]
    v_and_b32_dpp v96, v96, v136 wave_shr:1 row_mask:0xf bank_mask:0xf bound_ctrl:0
    v_and_b32_dpp v97, v97, v136 wave_shr:1 row_mask:0xf bank_mask:0xf bound_ctrl:0
    v_and_b32_dpp v98, v98, v136 wave_shr:1 row_mask:0xf bank_mask:0xf bound_ctrl:0
    v_and_b32_dpp v99, v99, v136 wave_shr:1 row_mask:0xf bank_mask:0xf bound_ctrl:0
    v_and_b32_dpp v100, v100, v136 wave_shr:1 row_mask:0xf bank_mask:0xf bound_ctrl:0
    v_and_b32_dpp v101, v101, v136 wave_shr:1 row_mask:0xf bank_mask:0xf bound_ctrl:0
    v_and_b32_dpp v102, v102, v136 wave_shr:1 row_mask:0xf bank_mask:0xf bound_ctrl:0
    v_and_b32_dpp v103, v103, v136 wave_shr:1 row_mask:0xf bank_mask:0xf bound_ctrl:0
    ds_read_b64 v[120:121], v11 offset:672
    ds_read_b64 v[122:123], v11 offset:680
    ds_read_b64 v[124:125], v11 offset:736
    ds_read_b64 v[126:127], v11 offset:744
    ds_read_b64 v[128:129], v11 offset:640
    ds_read_b64 v[130:131], v11 offset:648
    ds_read_b64 v[132:133], v11 offset:704
    ds_read_b64 v[134:135], v11 offset:712
    s_waitcnt lgkmcnt(8)
    v_mfma_f32_32x32x16_bf16 v[64:79], v[104:107], v[96:99], v[64:79]
    v_mfma_f32_32x32x16_bf16 v[80:95], v[108:111], v[96:99], v[80:95]
    v_mfma_f32_32x32x16_bf16 v[64:79], v[112:115], v[100:103], v[64:79]
    v_mfma_f32_32x32x16_bf16 v[80:95], v[116:119], v[100:103], v[80:95]
    v_and_b32_dpp v96, v96, v136 wave_shr:1 row_mask:0xf bank_mask:0xf bound_ctrl:0
    v_and_b32_dpp v97, v97, v136 wave_shr:1 row_mask:0xf bank_mask:0xf bound_ctrl:0
    v_and_b32_dpp v98, v98, v136 wave_shr:1 row_mask:0xf bank_mask:0xf bound_ctrl:0
    v_and_b32_dpp v99, v99, v136 wave_shr:1 row_mask:0xf bank_mask:0xf bound_ctrl:0
    v_and_b32_dpp v100, v100, v136 wave_shr:1 row_mask:0xf bank_mask:0xf bound_ctrl:0
    v_and_b32_dpp v101, v101, v136 wave_shr:1 row_mask:0xf bank_mask:0xf bound_ctrl:0
    v_and_b32_dpp v102, v102, v136 wave_shr:1 row_mask:0xf bank_mask:0xf bound_ctrl:0
    v_and_b32_dpp v103, v103, v136 wave_shr:1 row_mask:0xf bank_mask:0xf bound_ctrl:0
    ds_read_b64 v[104:105], v11 offset:800
    ds_read_b64 v[106:107], v11 offset:808
    ds_read_b64 v[108:109], v11 offset:864
    ds_read_b64 v[110:111], v11 offset:872
    ds_read_b64 v[112:113], v11 offset:768
    ds_read_b64 v[114:115], v11 offset:776
    ds_read_b64 v[116:117], v11 offset:832
    ds_read_b64 v[118:119], v11 offset:840
    s_waitcnt lgkmcnt(8)
    v_mfma_f32_32x32x16_bf16 v[64:79], v[120:123], v[96:99], v[64:79]
    v_mfma_f32_32x32x16_bf16 v[80:95], v[124:127], v[96:99], v[80:95]
    v_mfma_f32_32x32x16_bf16 v[64:79], v[128:131], v[100:103], v[64:79]
    v_mfma_f32_32x32x16_bf16 v[80:95], v[132:135], v[100:103], v[80:95]
    v_and_b32_dpp v96, v96, v136 wave_shr:1 row_mask:0xf bank_mask:0xf bound_ctrl:0
    v_and_b32_dpp v97, v97, v136 wave_shr:1 row_mask:0xf bank_mask:0xf bound_ctrl:0
    v_and_b32_dpp v98, v98, v136 wave_shr:1 row_mask:0xf bank_mask:0xf bound_ctrl:0
    v_and_b32_dpp v99, v99, v136 wave_shr:1 row_mask:0xf bank_mask:0xf bound_ctrl:0
    v_and_b32_dpp v100, v100, v136 wave_shr:1 row_mask:0xf bank_mask:0xf bound_ctrl:0
    v_and_b32_dpp v101, v101, v136 wave_shr:1 row_mask:0xf bank_mask:0xf bound_ctrl:0
    v_and_b32_dpp v102, v102, v136 wave_shr:1 row_mask:0xf bank_mask:0xf bound_ctrl:0
    v_and_b32_dpp v103, v103, v136 wave_shr:1 row_mask:0xf bank_mask:0xf bound_ctrl:0
    ds_read_b64 v[120:121], v11 offset:928
    ds_read_b64 v[122:123], v11 offset:936
    ds_read_b64 v[124:125], v11 offset:992
    ds_read_b64 v[126:127], v11 offset:1000
    ds_read_b64 v[128:129], v11 offset:896
    ds_read_b64 v[130:131], v11 offset:904
    ds_read_b64 v[132:133], v11 offset:960
    ds_read_b64 v[134:135], v11 offset:968
    s_waitcnt lgkmcnt(8)
    v_mfma_f32_32x32x16_bf16 v[64:79], v[104:107], v[96:99], v[64:79]
    v_mfma_f32_32x32x16_bf16 v[80:95], v[108:111], v[96:99], v[80:95]
    v_mfma_f32_32x32x16_bf16 v[64:79], v[112:115], v[100:103], v[64:79]
    v_mfma_f32_32x32x16_bf16 v[80:95], v[116:119], v[100:103], v[80:95]
    v_and_b32_dpp v96, v96, v136 wave_shr:1 row_mask:0xf bank_mask:0xf bound_ctrl:0
    v_and_b32_dpp v97, v97, v136 wave_shr:1 row_mask:0xf bank_mask:0xf bound_ctrl:0
    v_and_b32_dpp v98, v98, v136 wave_shr:1 row_mask:0xf bank_mask:0xf bound_ctrl:0
    v_and_b32_dpp v99, v99, v136 wave_shr:1 row_mask:0xf bank_mask:0xf bound_ctrl:0
    v_and_b32_dpp v100, v100, v136 wave_shr:1 row_mask:0xf bank_mask:0xf bound_ctrl:0
    v_and_b32_dpp v101, v101, v136 wave_shr:1 row_mask:0xf bank_mask:0xf bound_ctrl:0
    v_and_b32_dpp v102, v102, v136 wave_shr:1 row_mask:0xf bank_mask:0xf bound_ctrl:0
    v_and_b32_dpp v103, v103, v136 wave_shr:1 row_mask:0xf bank_mask:0xf bound_ctrl:0
    ds_read_b64 v[104:105], v11 offset:1056
    ds_read_b64 v[106:107], v11 offset:1064
    ds_read_b64 v[108:109], v11 offset:1120
    ds_read_b64 v[110:111], v11 offset:1128
    ds_read_b64 v[112:113], v11 offset:1024
    ds_read_b64 v[114:115], v11 offset:1032
    ds_read_b64 v[116:117], v11 offset:1088
    ds_read_b64 v[118:119], v11 offset:1096
    s_waitcnt lgkmcnt(8)
    v_mfma_f32_32x32x16_bf16 v[64:79], v[120:123], v[96:99], v[64:79]
    v_mfma_f32_32x32x16_bf16 v[80:95], v[124:127], v[96:99], v[80:95]
    v_mfma_f32_32x32x16_bf16 v[64:79], v[128:131], v[100:103], v[64:79]
    v_mfma_f32_32x32x16_bf16 v[80:95], v[132:135], v[100:103], v[80:95]
    v_and_b32_dpp v96, v96, v136 wave_shr:1 row_mask:0xf bank_mask:0xf bound_ctrl:0
    v_and_b32_dpp v97, v97, v136 wave_shr:1 row_mask:0xf bank_mask:0xf bound_ctrl:0
    v_and_b32_dpp v98, v98, v136 wave_shr:1 row_mask:0xf bank_mask:0xf bound_ctrl:0
    v_and_b32_dpp v99, v99, v136 wave_shr:1 row_mask:0xf bank_mask:0xf bound_ctrl:0
    v_and_b32_dpp v100, v100, v136 wave_shr:1 row_mask:0xf bank_mask:0xf bound_ctrl:0
    v_and_b32_dpp v101, v101, v136 wave_shr:1 row_mask:0xf bank_mask:0xf bound_ctrl:0
    v_and_b32_dpp v102, v102, v136 wave_shr:1 row_mask:0xf bank_mask:0xf bound_ctrl:0
    v_and_b32_dpp v103, v103, v136 wave_shr:1 row_mask:0xf bank_mask:0xf bound_ctrl:0
    ds_read_b64 v[120:121], v11 offset:1184
    ds_read_b64 v[122:123], v11 offset:1192
    ds_read_b64 v[124:125], v11 offset:1248
    ds_read_b64 v[126:127], v11 offset:1256
    ds_read_b64 v[128:129], v11 offset:1152
    ds_read_b64 v[130:131], v11 offset:1160
    ds_read_b64 v[132:133], v11 offset:1216
    ds_read_b64 v[134:135], v11 offset:1224
    s_waitcnt lgkmcnt(8)
    v_mfma_f32_32x32x16_bf16 v[64:79], v[104:107], v[96:99], v[64:79]
    v_mfma_f32_32x32x16_bf16 v[80:95], v[108:111], v[96:99], v[80:95]
    v_mfma_f32_32x32x16_bf16 v[64:79], v[112:115], v[100:103], v[64:79]
    v_mfma_f32_32x32x16_bf16 v[80:95], v[116:119], v[100:103], v[80:95]
    v_and_b32_dpp v96, v96, v136 wave_shr:1 row_mask:0xf bank_mask:0xf bound_ctrl:0
    v_and_b32_dpp v97, v97, v136 wave_shr:1 row_mask:0xf bank_mask:0xf bound_ctrl:0
    v_and_b32_dpp v98, v98, v136 wave_shr:1 row_mask:0xf bank_mask:0xf bound_ctrl:0
    v_and_b32_dpp v99, v99, v136 wave_shr:1 row_mask:0xf bank_mask:0xf bound_ctrl:0
    v_and_b32_dpp v100, v100, v136 wave_shr:1 row_mask:0xf bank_mask:0xf bound_ctrl:0
    v_and_b32_dpp v101, v101, v136 wave_shr:1 row_mask:0xf bank_mask:0xf bound_ctrl:0
    v_and_b32_dpp v102, v102, v136 wave_shr:1 row_mask:0xf bank_mask:0xf bound_ctrl:0
    v_and_b32_dpp v103, v103, v136 wave_shr:1 row_mask:0xf bank_mask:0xf bound_ctrl:0
    ds_read_b64 v[104:105], v11 offset:1312
    ds_read_b64 v[106:107], v11 offset:1320
    ds_read_b64 v[108:109], v11 offset:1376
    ds_read_b64 v[110:111], v11 offset:1384
    ds_read_b64 v[112:113], v11 offset:1280
    ds_read_b64 v[114:115], v11 offset:1288
    ds_read_b64 v[116:117], v11 offset:1344
    ds_read_b64 v[118:119], v11 offset:1352
    s_waitcnt lgkmcnt(8)
    v_mfma_f32_32x32x16_bf16 v[64:79], v[120:123], v[96:99], v[64:79]
    v_mfma_f32_32x32x16_bf16 v[80:95], v[124:127], v[96:99], v[80:95]
    v_mfma_f32_32x32x16_bf16 v[64:79], v[128:131], v[100:103], v[64:79]
    v_mfma_f32_32x32x16_bf16 v[80:95], v[132:135], v[100:103], v[80:95]
    v_and_b32_dpp v96, v96, v136 wave_shr:1 row_mask:0xf bank_mask:0xf bound_ctrl:0
    v_and_b32_dpp v97, v97, v136 wave_shr:1 row_mask:0xf bank_mask:0xf bound_ctrl:0
    v_and_b32_dpp v98, v98, v136 wave_shr:1 row_mask:0xf bank_mask:0xf bound_ctrl:0
    v_and_b32_dpp v99, v99, v136 wave_shr:1 row_mask:0xf bank_mask:0xf bound_ctrl:0
    v_and_b32_dpp v100, v100, v136 wave_shr:1 row_mask:0xf bank_mask:0xf bound_ctrl:0
    v_and_b32_dpp v101, v101, v136 wave_shr:1 row_mask:0xf bank_mask:0xf bound_ctrl:0
    v_and_b32_dpp v102, v102, v136 wave_shr:1 row_mask:0xf bank_mask:0xf bound_ctrl:0
    v_and_b32_dpp v103, v103, v136 wave_shr:1 row_mask:0xf bank_mask:0xf bound_ctrl:0
    ds_read_b64 v[120:121], v11 offset:1440
    ds_read_b64 v[122:123], v11 offset:1448
    ds_read_b64 v[124:125], v11 offset:1504
    ds_read_b64 v[126:127], v11 offset:1512
    ds_read_b64 v[128:129], v11 offset:1408
    ds_read_b64 v[130:131], v11 offset:1416
    ds_read_b64 v[132:133], v11 offset:1472
    ds_read_b64 v[134:135], v11 offset:1480
    s_waitcnt lgkmcnt(8)
    v_mfma_f32_32x32x16_bf16 v[64:79], v[104:107], v[96:99], v[64:79]
    v_mfma_f32_32x32x16_bf16 v[80:95], v[108:111], v[96:99], v[80:95]
    v_mfma_f32_32x32x16_bf16 v[64:79], v[112:115], v[100:103], v[64:79]
    v_mfma_f32_32x32x16_bf16 v[80:95], v[116:119], v[100:103], v[80:95]
    v_and_b32_dpp v96, v96, v136 wave_shr:1 row_mask:0xf bank_mask:0xf bound_ctrl:0
    v_and_b32_dpp v97, v97, v136 wave_shr:1 row_mask:0xf bank_mask:0xf bound_ctrl:0
    v_and_b32_dpp v98, v98, v136 wave_shr:1 row_mask:0xf bank_mask:0xf bound_ctrl:0
    v_and_b32_dpp v99, v99, v136 wave_shr:1 row_mask:0xf bank_mask:0xf bound_ctrl:0
    v_and_b32_dpp v100, v100, v136 wave_shr:1 row_mask:0xf bank_mask:0xf bound_ctrl:0
    v_and_b32_dpp v101, v101, v136 wave_shr:1 row_mask:0xf bank_mask:0xf bound_ctrl:0
    v_and_b32_dpp v102, v102, v136 wave_shr:1 row_mask:0xf bank_mask:0xf bound_ctrl:0
    v_and_b32_dpp v103, v103, v136 wave_shr:1 row_mask:0xf bank_mask:0xf bound_ctrl:0
    ds_read_b64 v[104:105], v11 offset:1568
    ds_read_b64 v[106:107], v11 offset:1576
    ds_read_b64 v[108:109], v11 offset:1632
    ds_read_b64 v[110:111], v11 offset:1640
    ds_read_b64 v[112:113], v11 offset:1536
    ds_read_b64 v[114:115], v11 offset:1544
    ds_read_b64 v[116:117], v11 offset:1600
    ds_read_b64 v[118:119], v11 offset:1608
    s_waitcnt lgkmcnt(8)
    v_mfma_f32_32x32x16_bf16 v[64:79], v[120:123], v[96:99], v[64:79]
    v_mfma_f32_32x32x16_bf16 v[80:95], v[124:127], v[96:99], v[80:95]
    v_mfma_f32_32x32x16_bf16 v[64:79], v[128:131], v[100:103], v[64:79]
    v_mfma_f32_32x32x16_bf16 v[80:95], v[132:135], v[100:103], v[80:95]
    v_and_b32_dpp v96, v96, v136 wave_shr:1 row_mask:0xf bank_mask:0xf bound_ctrl:0
    v_and_b32_dpp v97, v97, v136 wave_shr:1 row_mask:0xf bank_mask:0xf bound_ctrl:0
    v_and_b32_dpp v98, v98, v136 wave_shr:1 row_mask:0xf bank_mask:0xf bound_ctrl:0
    v_and_b32_dpp v99, v99, v136 wave_shr:1 row_mask:0xf bank_mask:0xf bound_ctrl:0
    v_and_b32_dpp v100, v100, v136 wave_shr:1 row_mask:0xf bank_mask:0xf bound_ctrl:0
    v_and_b32_dpp v101, v101, v136 wave_shr:1 row_mask:0xf bank_mask:0xf bound_ctrl:0
    v_and_b32_dpp v102, v102, v136 wave_shr:1 row_mask:0xf bank_mask:0xf bound_ctrl:0
    v_and_b32_dpp v103, v103, v136 wave_shr:1 row_mask:0xf bank_mask:0xf bound_ctrl:0
    ds_read_b64 v[120:121], v11 offset:1696
    ds_read_b64 v[122:123], v11 offset:1704
    ds_read_b64 v[124:125], v11 offset:1760
    ds_read_b64 v[126:127], v11 offset:1768
    ds_read_b64 v[128:129], v11 offset:1664
    ds_read_b64 v[130:131], v11 offset:1672
    ds_read_b64 v[132:133], v11 offset:1728
    ds_read_b64 v[134:135], v11 offset:1736
    s_waitcnt lgkmcnt(8)
    v_mfma_f32_32x32x16_bf16 v[64:79], v[104:107], v[96:99], v[64:79]
    v_mfma_f32_32x32x16_bf16 v[80:95], v[108:111], v[96:99], v[80:95]
    v_mfma_f32_32x32x16_bf16 v[64:79], v[112:115], v[100:103], v[64:79]
    v_mfma_f32_32x32x16_bf16 v[80:95], v[116:119], v[100:103], v[80:95]
    v_and_b32_dpp v96, v96, v136 wave_shr:1 row_mask:0xf bank_mask:0xf bound_ctrl:0
    v_and_b32_dpp v97, v97, v136 wave_shr:1 row_mask:0xf bank_mask:0xf bound_ctrl:0
    v_and_b32_dpp v98, v98, v136 wave_shr:1 row_mask:0xf bank_mask:0xf bound_ctrl:0
    v_and_b32_dpp v99, v99, v136 wave_shr:1 row_mask:0xf bank_mask:0xf bound_ctrl:0
    v_and_b32_dpp v100, v100, v136 wave_shr:1 row_mask:0xf bank_mask:0xf bound_ctrl:0
    v_and_b32_dpp v101, v101, v136 wave_shr:1 row_mask:0xf bank_mask:0xf bound_ctrl:0
    v_and_b32_dpp v102, v102, v136 wave_shr:1 row_mask:0xf bank_mask:0xf bound_ctrl:0
    v_and_b32_dpp v103, v103, v136 wave_shr:1 row_mask:0xf bank_mask:0xf bound_ctrl:0
    ds_read_b64 v[104:105], v11 offset:1824
    ds_read_b64 v[106:107], v11 offset:1832
    ds_read_b64 v[108:109], v11 offset:1888
    ds_read_b64 v[110:111], v11 offset:1896
    ds_read_b64 v[112:113], v11 offset:1792
    ds_read_b64 v[114:115], v11 offset:1800
    ds_read_b64 v[116:117], v11 offset:1856
    ds_read_b64 v[118:119], v11 offset:1864
    s_waitcnt lgkmcnt(8)
    v_mfma_f32_32x32x16_bf16 v[64:79], v[120:123], v[96:99], v[64:79]
    v_mfma_f32_32x32x16_bf16 v[80:95], v[124:127], v[96:99], v[80:95]
    v_mfma_f32_32x32x16_bf16 v[64:79], v[128:131], v[100:103], v[64:79]
    v_mfma_f32_32x32x16_bf16 v[80:95], v[132:135], v[100:103], v[80:95]
    v_and_b32_dpp v96, v96, v136 wave_shr:1 row_mask:0xf bank_mask:0xf bound_ctrl:0
    v_and_b32_dpp v97, v97, v136 wave_shr:1 row_mask:0xf bank_mask:0xf bound_ctrl:0
    v_and_b32_dpp v98, v98, v136 wave_shr:1 row_mask:0xf bank_mask:0xf bound_ctrl:0
    v_and_b32_dpp v99, v99, v136 wave_shr:1 row_mask:0xf bank_mask:0xf bound_ctrl:0
    v_and_b32_dpp v100, v100, v136 wave_shr:1 row_mask:0xf bank_mask:0xf bound_ctrl:0
    v_and_b32_dpp v101, v101, v136 wave_shr:1 row_mask:0xf bank_mask:0xf bound_ctrl:0
    v_and_b32_dpp v102, v102, v136 wave_shr:1 row_mask:0xf bank_mask:0xf bound_ctrl:0
    v_and_b32_dpp v103, v103, v136 wave_shr:1 row_mask:0xf bank_mask:0xf bound_ctrl:0
    ds_read_b64 v[120:121], v11 offset:1952
    ds_read_b64 v[122:123], v11 offset:1960
    ds_read_b64 v[124:125], v11 offset:2016
    ds_read_b64 v[126:127], v11 offset:2024
    ds_read_b64 v[128:129], v11 offset:1920
    ds_read_b64 v[130:131], v11 offset:1928
    ds_read_b64 v[132:133], v11 offset:1984
    ds_read_b64 v[134:135], v11 offset:1992
    s_waitcnt lgkmcnt(8)
    v_mfma_f32_32x32x16_bf16 v[64:79], v[104:107], v[96:99], v[64:79]
    v_mfma_f32_32x32x16_bf16 v[80:95], v[108:111], v[96:99], v[80:95]
    v_mfma_f32_32x32x16_bf16 v[64:79], v[112:115], v[100:103], v[64:79]
    v_mfma_f32_32x32x16_bf16 v[80:95], v[116:119], v[100:103], v[80:95]
    v_and_b32_dpp v96, v96, v136 wave_shr:1 row_mask:0xf bank_mask:0xf bound_ctrl:0
    v_and_b32_dpp v97, v97, v136 wave_shr:1 row_mask:0xf bank_mask:0xf bound_ctrl:0
    v_and_b32_dpp v98, v98, v136 wave_shr:1 row_mask:0xf bank_mask:0xf bound_ctrl:0
    v_and_b32_dpp v99, v99, v136 wave_shr:1 row_mask:0xf bank_mask:0xf bound_ctrl:0
    v_and_b32_dpp v100, v100, v136 wave_shr:1 row_mask:0xf bank_mask:0xf bound_ctrl:0
    v_and_b32_dpp v101, v101, v136 wave_shr:1 row_mask:0xf bank_mask:0xf bound_ctrl:0
    v_and_b32_dpp v102, v102, v136 wave_shr:1 row_mask:0xf bank_mask:0xf bound_ctrl:0
    v_and_b32_dpp v103, v103, v136 wave_shr:1 row_mask:0xf bank_mask:0xf bound_ctrl:0
    ds_read_b64 v[104:105], v11 offset:2080
    ds_read_b64 v[106:107], v11 offset:2088
    ds_read_b64 v[108:109], v11 offset:2144
    ds_read_b64 v[110:111], v11 offset:2152
    ds_read_b64 v[112:113], v11 offset:2048
    ds_read_b64 v[114:115], v11 offset:2056
    ds_read_b64 v[116:117], v11 offset:2112
    ds_read_b64 v[118:119], v11 offset:2120
    s_waitcnt lgkmcnt(8)
    v_mfma_f32_32x32x16_bf16 v[64:79], v[120:123], v[96:99], v[64:79]
    v_mfma_f32_32x32x16_bf16 v[80:95], v[124:127], v[96:99], v[80:95]
    v_mfma_f32_32x32x16_bf16 v[64:79], v[128:131], v[100:103], v[64:79]
    v_mfma_f32_32x32x16_bf16 v[80:95], v[132:135], v[100:103], v[80:95]
    v_and_b32_dpp v96, v96, v136 wave_shr:1 row_mask:0xf bank_mask:0xf bound_ctrl:0
    v_and_b32_dpp v97, v97, v136 wave_shr:1 row_mask:0xf bank_mask:0xf bound_ctrl:0
    v_and_b32_dpp v98, v98, v136 wave_shr:1 row_mask:0xf bank_mask:0xf bound_ctrl:0
    v_and_b32_dpp v99, v99, v136 wave_shr:1 row_mask:0xf bank_mask:0xf bound_ctrl:0
    v_and_b32_dpp v100, v100, v136 wave_shr:1 row_mask:0xf bank_mask:0xf bound_ctrl:0
    v_and_b32_dpp v101, v101, v136 wave_shr:1 row_mask:0xf bank_mask:0xf bound_ctrl:0
    v_and_b32_dpp v102, v102, v136 wave_shr:1 row_mask:0xf bank_mask:0xf bound_ctrl:0
    v_and_b32_dpp v103, v103, v136 wave_shr:1 row_mask:0xf bank_mask:0xf bound_ctrl:0
    ds_read_b64 v[120:121], v11 offset:2208
    ds_read_b64 v[122:123], v11 offset:2216
    ds_read_b64 v[124:125], v11 offset:2272
    ds_read_b64 v[126:127], v11 offset:2280
    ds_read_b64 v[128:129], v11 offset:2176
    ds_read_b64 v[130:131], v11 offset:2184
    ds_read_b64 v[132:133], v11 offset:2240
    ds_read_b64 v[134:135], v11 offset:2248
    s_waitcnt lgkmcnt(8)
    v_mfma_f32_32x32x16_bf16 v[64:79], v[104:107], v[96:99], v[64:79]
    v_mfma_f32_32x32x16_bf16 v[80:95], v[108:111], v[96:99], v[80:95]
    v_mfma_f32_32x32x16_bf16 v[64:79], v[112:115], v[100:103], v[64:79]
    v_mfma_f32_32x32x16_bf16 v[80:95], v[116:119], v[100:103], v[80:95]
    v_and_b32_dpp v96, v96, v136 wave_shr:1 row_mask:0xf bank_mask:0xf bound_ctrl:0
    v_and_b32_dpp v97, v97, v136 wave_shr:1 row_mask:0xf bank_mask:0xf bound_ctrl:0
    v_and_b32_dpp v98, v98, v136 wave_shr:1 row_mask:0xf bank_mask:0xf bound_ctrl:0
    v_and_b32_dpp v99, v99, v136 wave_shr:1 row_mask:0xf bank_mask:0xf bound_ctrl:0
    v_and_b32_dpp v100, v100, v136 wave_shr:1 row_mask:0xf bank_mask:0xf bound_ctrl:0
    v_and_b32_dpp v101, v101, v136 wave_shr:1 row_mask:0xf bank_mask:0xf bound_ctrl:0
    v_and_b32_dpp v102, v102, v136 wave_shr:1 row_mask:0xf bank_mask:0xf bound_ctrl:0
    v_and_b32_dpp v103, v103, v136 wave_shr:1 row_mask:0xf bank_mask:0xf bound_ctrl:0
    ds_read_b64 v[104:105], v11 offset:2336
    ds_read_b64 v[106:107], v11 offset:2344
    ds_read_b64 v[108:109], v11 offset:2400
    ds_read_b64 v[110:111], v11 offset:2408
    ds_read_b64 v[112:113], v11 offset:2304
    ds_read_b64 v[114:115], v11 offset:2312
    ds_read_b64 v[116:117], v11 offset:2368
    ds_read_b64 v[118:119], v11 offset:2376
    s_waitcnt lgkmcnt(8)
    v_mfma_f32_32x32x16_bf16 v[64:79], v[120:123], v[96:99], v[64:79]
    v_mfma_f32_32x32x16_bf16 v[80:95], v[124:127], v[96:99], v[80:95]
    v_mfma_f32_32x32x16_bf16 v[64:79], v[128:131], v[100:103], v[64:79]
    v_mfma_f32_32x32x16_bf16 v[80:95], v[132:135], v[100:103], v[80:95]
    v_and_b32_dpp v96, v96, v136 wave_shr:1 row_mask:0xf bank_mask:0xf bound_ctrl:0
    v_and_b32_dpp v97, v97, v136 wave_shr:1 row_mask:0xf bank_mask:0xf bound_ctrl:0
    v_and_b32_dpp v98, v98, v136 wave_shr:1 row_mask:0xf bank_mask:0xf bound_ctrl:0
    v_and_b32_dpp v99, v99, v136 wave_shr:1 row_mask:0xf bank_mask:0xf bound_ctrl:0
    v_and_b32_dpp v100, v100, v136 wave_shr:1 row_mask:0xf bank_mask:0xf bound_ctrl:0
    v_and_b32_dpp v101, v101, v136 wave_shr:1 row_mask:0xf bank_mask:0xf bound_ctrl:0
    v_and_b32_dpp v102, v102, v136 wave_shr:1 row_mask:0xf bank_mask:0xf bound_ctrl:0
    v_and_b32_dpp v103, v103, v136 wave_shr:1 row_mask:0xf bank_mask:0xf bound_ctrl:0
    ds_read_b64 v[120:121], v11 offset:2464
    ds_read_b64 v[122:123], v11 offset:2472
    ds_read_b64 v[124:125], v11 offset:2528
    ds_read_b64 v[126:127], v11 offset:2536
    ds_read_b64 v[128:129], v11 offset:2432
    ds_read_b64 v[130:131], v11 offset:2440
    ds_read_b64 v[132:133], v11 offset:2496
    ds_read_b64 v[134:135], v11 offset:2504
    s_waitcnt lgkmcnt(8)
    v_mfma_f32_32x32x16_bf16 v[64:79], v[104:107], v[96:99], v[64:79]
    v_mfma_f32_32x32x16_bf16 v[80:95], v[108:111], v[96:99], v[80:95]
    v_mfma_f32_32x32x16_bf16 v[64:79], v[112:115], v[100:103], v[64:79]
    v_mfma_f32_32x32x16_bf16 v[80:95], v[116:119], v[100:103], v[80:95]
    v_and_b32_dpp v96, v96, v136 wave_shr:1 row_mask:0xf bank_mask:0xf bound_ctrl:0
    v_and_b32_dpp v97, v97, v136 wave_shr:1 row_mask:0xf bank_mask:0xf bound_ctrl:0
    v_and_b32_dpp v98, v98, v136 wave_shr:1 row_mask:0xf bank_mask:0xf bound_ctrl:0
    v_and_b32_dpp v99, v99, v136 wave_shr:1 row_mask:0xf bank_mask:0xf bound_ctrl:0
    v_and_b32_dpp v100, v100, v136 wave_shr:1 row_mask:0xf bank_mask:0xf bound_ctrl:0
    v_and_b32_dpp v101, v101, v136 wave_shr:1 row_mask:0xf bank_mask:0xf bound_ctrl:0
    v_and_b32_dpp v102, v102, v136 wave_shr:1 row_mask:0xf bank_mask:0xf bound_ctrl:0
    v_and_b32_dpp v103, v103, v136 wave_shr:1 row_mask:0xf bank_mask:0xf bound_ctrl:0
    ds_read_b64 v[104:105], v11 offset:2592
    ds_read_b64 v[106:107], v11 offset:2600
    ds_read_b64 v[108:109], v11 offset:2656
    ds_read_b64 v[110:111], v11 offset:2664
    ds_read_b64 v[112:113], v11 offset:2560
    ds_read_b64 v[114:115], v11 offset:2568
    ds_read_b64 v[116:117], v11 offset:2624
    ds_read_b64 v[118:119], v11 offset:2632
    s_waitcnt lgkmcnt(8)
    v_mfma_f32_32x32x16_bf16 v[64:79], v[120:123], v[96:99], v[64:79]
    v_mfma_f32_32x32x16_bf16 v[80:95], v[124:127], v[96:99], v[80:95]
    v_mfma_f32_32x32x16_bf16 v[64:79], v[128:131], v[100:103], v[64:79]
    v_mfma_f32_32x32x16_bf16 v[80:95], v[132:135], v[100:103], v[80:95]
    v_and_b32_dpp v96, v96, v136 wave_shr:1 row_mask:0xf bank_mask:0xf bound_ctrl:0
    v_and_b32_dpp v97, v97, v136 wave_shr:1 row_mask:0xf bank_mask:0xf bound_ctrl:0
    v_and_b32_dpp v98, v98, v136 wave_shr:1 row_mask:0xf bank_mask:0xf bound_ctrl:0
    v_and_b32_dpp v99, v99, v136 wave_shr:1 row_mask:0xf bank_mask:0xf bound_ctrl:0
    v_and_b32_dpp v100, v100, v136 wave_shr:1 row_mask:0xf bank_mask:0xf bound_ctrl:0
    v_and_b32_dpp v101, v101, v136 wave_shr:1 row_mask:0xf bank_mask:0xf bound_ctrl:0
    v_and_b32_dpp v102, v102, v136 wave_shr:1 row_mask:0xf bank_mask:0xf bound_ctrl:0
    v_and_b32_dpp v103, v103, v136 wave_shr:1 row_mask:0xf bank_mask:0xf bound_ctrl:0
    ds_read_b64 v[120:121], v11 offset:2720
    ds_read_b64 v[122:123], v11 offset:2728
    ds_read_b64 v[124:125], v11 offset:2784
    ds_read_b64 v[126:127], v11 offset:2792
    ds_read_b64 v[128:129], v11 offset:2688
    ds_read_b64 v[130:131], v11 offset:2696
    ds_read_b64 v[132:133], v11 offset:2752
    ds_read_b64 v[134:135], v11 offset:2760
    s_waitcnt lgkmcnt(8)
    v_mfma_f32_32x32x16_bf16 v[64:79], v[104:107], v[96:99], v[64:79]
    v_mfma_f32_32x32x16_bf16 v[80:95], v[108:111], v[96:99], v[80:95]
    v_mfma_f32_32x32x16_bf16 v[64:79], v[112:115], v[100:103], v[64:79]
    v_mfma_f32_32x32x16_bf16 v[80:95], v[116:119], v[100:103], v[80:95]
    v_and_b32_dpp v96, v96, v136 wave_shr:1 row_mask:0xf bank_mask:0xf bound_ctrl:0
    v_and_b32_dpp v97, v97, v136 wave_shr:1 row_mask:0xf bank_mask:0xf bound_ctrl:0
    v_and_b32_dpp v98, v98, v136 wave_shr:1 row_mask:0xf bank_mask:0xf bound_ctrl:0
    v_and_b32_dpp v99, v99, v136 wave_shr:1 row_mask:0xf bank_mask:0xf bound_ctrl:0
    v_and_b32_dpp v100, v100, v136 wave_shr:1 row_mask:0xf bank_mask:0xf bound_ctrl:0
    v_and_b32_dpp v101, v101, v136 wave_shr:1 row_mask:0xf bank_mask:0xf bound_ctrl:0
    v_and_b32_dpp v102, v102, v136 wave_shr:1 row_mask:0xf bank_mask:0xf bound_ctrl:0
    v_and_b32_dpp v103, v103, v136 wave_shr:1 row_mask:0xf bank_mask:0xf bound_ctrl:0
    ds_read_b64 v[104:105], v11 offset:2848
    ds_read_b64 v[106:107], v11 offset:2856
    ds_read_b64 v[108:109], v11 offset:2912
    ds_read_b64 v[110:111], v11 offset:2920
    ds_read_b64 v[112:113], v11 offset:2816
    ds_read_b64 v[114:115], v11 offset:2824
    ds_read_b64 v[116:117], v11 offset:2880
    ds_read_b64 v[118:119], v11 offset:2888
    s_waitcnt lgkmcnt(8)
    v_mfma_f32_32x32x16_bf16 v[64:79], v[120:123], v[96:99], v[64:79]
    v_mfma_f32_32x32x16_bf16 v[80:95], v[124:127], v[96:99], v[80:95]
    v_mfma_f32_32x32x16_bf16 v[64:79], v[128:131], v[100:103], v[64:79]
    v_mfma_f32_32x32x16_bf16 v[80:95], v[132:135], v[100:103], v[80:95]
    v_and_b32_dpp v96, v96, v136 wave_shr:1 row_mask:0xf bank_mask:0xf bound_ctrl:0
    v_and_b32_dpp v97, v97, v136 wave_shr:1 row_mask:0xf bank_mask:0xf bound_ctrl:0
    v_and_b32_dpp v98, v98, v136 wave_shr:1 row_mask:0xf bank_mask:0xf bound_ctrl:0
    v_and_b32_dpp v99, v99, v136 wave_shr:1 row_mask:0xf bank_mask:0xf bound_ctrl:0
    v_and_b32_dpp v100, v100, v136 wave_shr:1 row_mask:0xf bank_mask:0xf bound_ctrl:0
    v_and_b32_dpp v101, v101, v136 wave_shr:1 row_mask:0xf bank_mask:0xf bound_ctrl:0
    v_and_b32_dpp v102, v102, v136 wave_shr:1 row_mask:0xf bank_mask:0xf bound_ctrl:0
    v_and_b32_dpp v103, v103, v136 wave_shr:1 row_mask:0xf bank_mask:0xf bound_ctrl:0
    ds_read_b64 v[120:121], v11 offset:2976
    ds_read_b64 v[122:123], v11 offset:2984
    ds_read_b64 v[124:125], v11 offset:3040
    ds_read_b64 v[126:127], v11 offset:3048
    ds_read_b64 v[128:129], v11 offset:2944
    ds_read_b64 v[130:131], v11 offset:2952
    ds_read_b64 v[132:133], v11 offset:3008
    ds_read_b64 v[134:135], v11 offset:3016
    s_waitcnt lgkmcnt(8)
    v_mfma_f32_32x32x16_bf16 v[64:79], v[104:107], v[96:99], v[64:79]
    v_mfma_f32_32x32x16_bf16 v[80:95], v[108:111], v[96:99], v[80:95]
    v_mfma_f32_32x32x16_bf16 v[64:79], v[112:115], v[100:103], v[64:79]
    v_mfma_f32_32x32x16_bf16 v[80:95], v[116:119], v[100:103], v[80:95]
    v_and_b32_dpp v96, v96, v136 wave_shr:1 row_mask:0xf bank_mask:0xf bound_ctrl:0
    v_and_b32_dpp v97, v97, v136 wave_shr:1 row_mask:0xf bank_mask:0xf bound_ctrl:0
    v_and_b32_dpp v98, v98, v136 wave_shr:1 row_mask:0xf bank_mask:0xf bound_ctrl:0
    v_and_b32_dpp v99, v99, v136 wave_shr:1 row_mask:0xf bank_mask:0xf bound_ctrl:0
    v_and_b32_dpp v100, v100, v136 wave_shr:1 row_mask:0xf bank_mask:0xf bound_ctrl:0
    v_and_b32_dpp v101, v101, v136 wave_shr:1 row_mask:0xf bank_mask:0xf bound_ctrl:0
    v_and_b32_dpp v102, v102, v136 wave_shr:1 row_mask:0xf bank_mask:0xf bound_ctrl:0
    v_and_b32_dpp v103, v103, v136 wave_shr:1 row_mask:0xf bank_mask:0xf bound_ctrl:0
    ds_read_b64 v[104:105], v11 offset:3104
    ds_read_b64 v[106:107], v11 offset:3112
    ds_read_b64 v[108:109], v11 offset:3168
    ds_read_b64 v[110:111], v11 offset:3176
    ds_read_b64 v[112:113], v11 offset:3072
    ds_read_b64 v[114:115], v11 offset:3080
    ds_read_b64 v[116:117], v11 offset:3136
    ds_read_b64 v[118:119], v11 offset:3144
    s_waitcnt lgkmcnt(8)
    v_mfma_f32_32x32x16_bf16 v[64:79], v[120:123], v[96:99], v[64:79]
    v_mfma_f32_32x32x16_bf16 v[80:95], v[124:127], v[96:99], v[80:95]
    v_mfma_f32_32x32x16_bf16 v[64:79], v[128:131], v[100:103], v[64:79]
    v_mfma_f32_32x32x16_bf16 v[80:95], v[132:135], v[100:103], v[80:95]
    v_and_b32_dpp v96, v96, v136 wave_shr:1 row_mask:0xf bank_mask:0xf bound_ctrl:0
    v_and_b32_dpp v97, v97, v136 wave_shr:1 row_mask:0xf bank_mask:0xf bound_ctrl:0
    v_and_b32_dpp v98, v98, v136 wave_shr:1 row_mask:0xf bank_mask:0xf bound_ctrl:0
    v_and_b32_dpp v99, v99, v136 wave_shr:1 row_mask:0xf bank_mask:0xf bound_ctrl:0
    v_and_b32_dpp v100, v100, v136 wave_shr:1 row_mask:0xf bank_mask:0xf bound_ctrl:0
    v_and_b32_dpp v101, v101, v136 wave_shr:1 row_mask:0xf bank_mask:0xf bound_ctrl:0
    v_and_b32_dpp v102, v102, v136 wave_shr:1 row_mask:0xf bank_mask:0xf bound_ctrl:0
    v_and_b32_dpp v103, v103, v136 wave_shr:1 row_mask:0xf bank_mask:0xf bound_ctrl:0
    ds_read_b64 v[120:121], v11 offset:3232
    ds_read_b64 v[122:123], v11 offset:3240
    ds_read_b64 v[124:125], v11 offset:3296
    ds_read_b64 v[126:127], v11 offset:3304
    ds_read_b64 v[128:129], v11 offset:3200
    ds_read_b64 v[130:131], v11 offset:3208
    ds_read_b64 v[132:133], v11 offset:3264
    ds_read_b64 v[134:135], v11 offset:3272
    s_waitcnt lgkmcnt(8)
    v_mfma_f32_32x32x16_bf16 v[64:79], v[104:107], v[96:99], v[64:79]
    v_mfma_f32_32x32x16_bf16 v[80:95], v[108:111], v[96:99], v[80:95]
    v_mfma_f32_32x32x16_bf16 v[64:79], v[112:115], v[100:103], v[64:79]
    v_mfma_f32_32x32x16_bf16 v[80:95], v[116:119], v[100:103], v[80:95]
    v_and_b32_dpp v96, v96, v136 wave_shr:1 row_mask:0xf bank_mask:0xf bound_ctrl:0
    v_and_b32_dpp v97, v97, v136 wave_shr:1 row_mask:0xf bank_mask:0xf bound_ctrl:0
    v_and_b32_dpp v98, v98, v136 wave_shr:1 row_mask:0xf bank_mask:0xf bound_ctrl:0
    v_and_b32_dpp v99, v99, v136 wave_shr:1 row_mask:0xf bank_mask:0xf bound_ctrl:0
    v_and_b32_dpp v100, v100, v136 wave_shr:1 row_mask:0xf bank_mask:0xf bound_ctrl:0
    v_and_b32_dpp v101, v101, v136 wave_shr:1 row_mask:0xf bank_mask:0xf bound_ctrl:0
    v_and_b32_dpp v102, v102, v136 wave_shr:1 row_mask:0xf bank_mask:0xf bound_ctrl:0
    v_and_b32_dpp v103, v103, v136 wave_shr:1 row_mask:0xf bank_mask:0xf bound_ctrl:0
    ds_read_b64 v[104:105], v11 offset:3360
    ds_read_b64 v[106:107], v11 offset:3368
    ds_read_b64 v[108:109], v11 offset:3424
    ds_read_b64 v[110:111], v11 offset:3432
    ds_read_b64 v[112:113], v11 offset:3328
    ds_read_b64 v[114:115], v11 offset:3336
    ds_read_b64 v[116:117], v11 offset:3392
    ds_read_b64 v[118:119], v11 offset:3400
    s_waitcnt lgkmcnt(8)
    v_mfma_f32_32x32x16_bf16 v[64:79], v[120:123], v[96:99], v[64:79]
    v_mfma_f32_32x32x16_bf16 v[80:95], v[124:127], v[96:99], v[80:95]
    v_mfma_f32_32x32x16_bf16 v[64:79], v[128:131], v[100:103], v[64:79]
    v_mfma_f32_32x32x16_bf16 v[80:95], v[132:135], v[100:103], v[80:95]
    v_and_b32_dpp v96, v96, v136 wave_shr:1 row_mask:0xf bank_mask:0xf bound_ctrl:0
    v_and_b32_dpp v97, v97, v136 wave_shr:1 row_mask:0xf bank_mask:0xf bound_ctrl:0
    v_and_b32_dpp v98, v98, v136 wave_shr:1 row_mask:0xf bank_mask:0xf bound_ctrl:0
    v_and_b32_dpp v99, v99, v136 wave_shr:1 row_mask:0xf bank_mask:0xf bound_ctrl:0
    v_and_b32_dpp v100, v100, v136 wave_shr:1 row_mask:0xf bank_mask:0xf bound_ctrl:0
    v_and_b32_dpp v101, v101, v136 wave_shr:1 row_mask:0xf bank_mask:0xf bound_ctrl:0
    v_and_b32_dpp v102, v102, v136 wave_shr:1 row_mask:0xf bank_mask:0xf bound_ctrl:0
    v_and_b32_dpp v103, v103, v136 wave_shr:1 row_mask:0xf bank_mask:0xf bound_ctrl:0
    ds_read_b64 v[120:121], v11 offset:3488
    ds_read_b64 v[122:123], v11 offset:3496
    ds_read_b64 v[124:125], v11 offset:3552
    ds_read_b64 v[126:127], v11 offset:3560
    ds_read_b64 v[128:129], v11 offset:3456
    ds_read_b64 v[130:131], v11 offset:3464
    ds_read_b64 v[132:133], v11 offset:3520
    ds_read_b64 v[134:135], v11 offset:3528
    s_waitcnt lgkmcnt(8)
    v_mfma_f32_32x32x16_bf16 v[64:79], v[104:107], v[96:99], v[64:79]
    v_mfma_f32_32x32x16_bf16 v[80:95], v[108:111], v[96:99], v[80:95]
    v_mfma_f32_32x32x16_bf16 v[64:79], v[112:115], v[100:103], v[64:79]
    v_mfma_f32_32x32x16_bf16 v[80:95], v[116:119], v[100:103], v[80:95]
    v_and_b32_dpp v96, v96, v136 wave_shr:1 row_mask:0xf bank_mask:0xf bound_ctrl:0
    v_and_b32_dpp v97, v97, v136 wave_shr:1 row_mask:0xf bank_mask:0xf bound_ctrl:0
    v_and_b32_dpp v98, v98, v136 wave_shr:1 row_mask:0xf bank_mask:0xf bound_ctrl:0
    v_and_b32_dpp v99, v99, v136 wave_shr:1 row_mask:0xf bank_mask:0xf bound_ctrl:0
    v_and_b32_dpp v100, v100, v136 wave_shr:1 row_mask:0xf bank_mask:0xf bound_ctrl:0
    v_and_b32_dpp v101, v101, v136 wave_shr:1 row_mask:0xf bank_mask:0xf bound_ctrl:0
    v_and_b32_dpp v102, v102, v136 wave_shr:1 row_mask:0xf bank_mask:0xf bound_ctrl:0
    v_and_b32_dpp v103, v103, v136 wave_shr:1 row_mask:0xf bank_mask:0xf bound_ctrl:0
    ds_read_b64 v[104:105], v11 offset:3616
    ds_read_b64 v[106:107], v11 offset:3624
    ds_read_b64 v[108:109], v11 offset:3680
    ds_read_b64 v[110:111], v11 offset:3688
    ds_read_b64 v[112:113], v11 offset:3584
    ds_read_b64 v[114:115], v11 offset:3592
    ds_read_b64 v[116:117], v11 offset:3648
    ds_read_b64 v[118:119], v11 offset:3656
    s_waitcnt lgkmcnt(8)
    v_mfma_f32_32x32x16_bf16 v[64:79], v[120:123], v[96:99], v[64:79]
    v_mfma_f32_32x32x16_bf16 v[80:95], v[124:127], v[96:99], v[80:95]
    v_mfma_f32_32x32x16_bf16 v[64:79], v[128:131], v[100:103], v[64:79]
    v_mfma_f32_32x32x16_bf16 v[80:95], v[132:135], v[100:103], v[80:95]
    v_and_b32_dpp v96, v96, v136 wave_shr:1 row_mask:0xf bank_mask:0xf bound_ctrl:0
    v_and_b32_dpp v97, v97, v136 wave_shr:1 row_mask:0xf bank_mask:0xf bound_ctrl:0
    v_and_b32_dpp v98, v98, v136 wave_shr:1 row_mask:0xf bank_mask:0xf bound_ctrl:0
    v_and_b32_dpp v99, v99, v136 wave_shr:1 row_mask:0xf bank_mask:0xf bound_ctrl:0
    v_and_b32_dpp v100, v100, v136 wave_shr:1 row_mask:0xf bank_mask:0xf bound_ctrl:0
    v_and_b32_dpp v101, v101, v136 wave_shr:1 row_mask:0xf bank_mask:0xf bound_ctrl:0
    v_and_b32_dpp v102, v102, v136 wave_shr:1 row_mask:0xf bank_mask:0xf bound_ctrl:0
    v_and_b32_dpp v103, v103, v136 wave_shr:1 row_mask:0xf bank_mask:0xf bound_ctrl:0
    ds_read_b64 v[120:121], v11 offset:3744
    ds_read_b64 v[122:123], v11 offset:3752
    ds_read_b64 v[124:125], v11 offset:3808
    ds_read_b64 v[126:127], v11 offset:3816
    ds_read_b64 v[128:129], v11 offset:3712
    ds_read_b64 v[130:131], v11 offset:3720
    ds_read_b64 v[132:133], v11 offset:3776
    ds_read_b64 v[134:135], v11 offset:3784
    s_waitcnt lgkmcnt(8)
    v_mfma_f32_32x32x16_bf16 v[64:79], v[104:107], v[96:99], v[64:79]
    v_mfma_f32_32x32x16_bf16 v[80:95], v[108:111], v[96:99], v[80:95]
    v_mfma_f32_32x32x16_bf16 v[64:79], v[112:115], v[100:103], v[64:79]
    v_mfma_f32_32x32x16_bf16 v[80:95], v[116:119], v[100:103], v[80:95]
    v_and_b32_dpp v96, v96, v136 wave_shr:1 row_mask:0xf bank_mask:0xf bound_ctrl:0
    v_and_b32_dpp v97, v97, v136 wave_shr:1 row_mask:0xf bank_mask:0xf bound_ctrl:0
    v_and_b32_dpp v98, v98, v136 wave_shr:1 row_mask:0xf bank_mask:0xf bound_ctrl:0
    v_and_b32_dpp v99, v99, v136 wave_shr:1 row_mask:0xf bank_mask:0xf bound_ctrl:0
    v_and_b32_dpp v100, v100, v136 wave_shr:1 row_mask:0xf bank_mask:0xf bound_ctrl:0
    v_and_b32_dpp v101, v101, v136 wave_shr:1 row_mask:0xf bank_mask:0xf bound_ctrl:0
    v_and_b32_dpp v102, v102, v136 wave_shr:1 row_mask:0xf bank_mask:0xf bound_ctrl:0
    v_and_b32_dpp v103, v103, v136 wave_shr:1 row_mask:0xf bank_mask:0xf bound_ctrl:0
    ds_read_b64 v[104:105], v11 offset:3872
    ds_read_b64 v[106:107], v11 offset:3880
    ds_read_b64 v[108:109], v11 offset:3936
    ds_read_b64 v[110:111], v11 offset:3944
    ds_read_b64 v[112:113], v11 offset:3840
    ds_read_b64 v[114:115], v11 offset:3848
    ds_read_b64 v[116:117], v11 offset:3904
    ds_read_b64 v[118:119], v11 offset:3912
    s_waitcnt lgkmcnt(8)
    v_mfma_f32_32x32x16_bf16 v[64:79], v[120:123], v[96:99], v[64:79]
    v_mfma_f32_32x32x16_bf16 v[80:95], v[124:127], v[96:99], v[80:95]
    v_mfma_f32_32x32x16_bf16 v[64:79], v[128:131], v[100:103], v[64:79]
    v_mfma_f32_32x32x16_bf16 v[80:95], v[132:135], v[100:103], v[80:95]
    v_and_b32_dpp v96, v96, v136 wave_shr:1 row_mask:0xf bank_mask:0xf bound_ctrl:0
    v_and_b32_dpp v97, v97, v136 wave_shr:1 row_mask:0xf bank_mask:0xf bound_ctrl:0
    v_and_b32_dpp v98, v98, v136 wave_shr:1 row_mask:0xf bank_mask:0xf bound_ctrl:0
    v_and_b32_dpp v99, v99, v136 wave_shr:1 row_mask:0xf bank_mask:0xf bound_ctrl:0
    v_and_b32_dpp v100, v100, v136 wave_shr:1 row_mask:0xf bank_mask:0xf bound_ctrl:0
    v_and_b32_dpp v101, v101, v136 wave_shr:1 row_mask:0xf bank_mask:0xf bound_ctrl:0
    v_and_b32_dpp v102, v102, v136 wave_shr:1 row_mask:0xf bank_mask:0xf bound_ctrl:0
    v_and_b32_dpp v103, v103, v136 wave_shr:1 row_mask:0xf bank_mask:0xf bound_ctrl:0
    ds_read_b64 v[120:121], v11 offset:4000
    ds_read_b64 v[122:123], v11 offset:4008
    ds_read_b64 v[124:125], v11 offset:4064
    ds_read_b64 v[126:127], v11 offset:4072
    ds_read_b64 v[128:129], v11 offset:3968
    ds_read_b64 v[130:131], v11 offset:3976
    ds_read_b64 v[132:133], v11 offset:4032
    ds_read_b64 v[134:135], v11 offset:4040
    s_waitcnt lgkmcnt(8)
    v_mfma_f32_32x32x16_bf16 v[64:79], v[104:107], v[96:99], v[64:79]
    v_mfma_f32_32x32x16_bf16 v[80:95], v[108:111], v[96:99], v[80:95]
    v_mfma_f32_32x32x16_bf16 v[64:79], v[112:115], v[100:103], v[64:79]
    v_mfma_f32_32x32x16_bf16 v[80:95], v[116:119], v[100:103], v[80:95]
    v_and_b32_dpp v96, v96, v136 wave_shr:1 row_mask:0xf bank_mask:0xf bound_ctrl:0
    v_and_b32_dpp v97, v97, v136 wave_shr:1 row_mask:0xf bank_mask:0xf bound_ctrl:0
    v_and_b32_dpp v98, v98, v136 wave_shr:1 row_mask:0xf bank_mask:0xf bound_ctrl:0
    v_and_b32_dpp v99, v99, v136 wave_shr:1 row_mask:0xf bank_mask:0xf bound_ctrl:0
    v_and_b32_dpp v100, v100, v136 wave_shr:1 row_mask:0xf bank_mask:0xf bound_ctrl:0
    v_and_b32_dpp v101, v101, v136 wave_shr:1 row_mask:0xf bank_mask:0xf bound_ctrl:0
    v_and_b32_dpp v102, v102, v136 wave_shr:1 row_mask:0xf bank_mask:0xf bound_ctrl:0
    v_and_b32_dpp v103, v103, v136 wave_shr:1 row_mask:0xf bank_mask:0xf bound_ctrl:0
    s_waitcnt lgkmcnt(0)
    v_mfma_f32_32x32x16_bf16 v[64:79], v[120:123], v[96:99], v[64:79]
    v_mfma_f32_32x32x16_bf16 v[80:95], v[124:127], v[96:99], v[80:95]
    v_mfma_f32_32x32x16_bf16 v[64:79], v[128:131], v[100:103], v[64:79]
    v_mfma_f32_32x32x16_bf16 v[80:95], v[132:135], v[100:103], v[80:95]
    s_nop 7
    s_nop 7
    s_barrier
    s_mul_i32 s46, s36, 4096
    s_add_u32 s46, s46, 0
    v_lshlrev_b32 v12, 4, v2
    v_add_u32 v12, s46, v12
    s_xor_b32 s47, s36, 1
    s_mul_i32 s47, s47, 4096
    s_add_u32 s47, s47, 0
    v_lshlrev_b32 v13, 4, v2
    v_add_u32 v13, s47, v13
    s_cmp_eq_u32 s38, 0
    s_cbranch_scc1 L_conv_ks0
    ds_write_b128 v12, v[64:67] offset:0
    ds_write_b128 v12, v[68:71] offset:1024
    ds_write_b128 v12, v[72:75] offset:2048
    ds_write_b128 v12, v[76:79] offset:3072
    s_waitcnt lgkmcnt(0)
    v_mov_b32 v64, v80
    v_mov_b32 v65, v81
    v_mov_b32 v66, v82
    v_mov_b32 v67, v83
    v_mov_b32 v68, v84
    v_mov_b32 v69, v85
    v_mov_b32 v70, v86
    v_mov_b32 v71, v87
    v_mov_b32 v72, v88
    v_mov_b32 v73, v89
    v_mov_b32 v74, v90
    v_mov_b32 v75, v91
    v_mov_b32 v76, v92
    v_mov_b32 v77, v93
    v_mov_b32 v78, v94
    v_mov_b32 v79, v95
    s_branch L_conv_xchg
L_conv_ks0:
    ds_write_b128 v12, v[80:83] offset:0
    ds_write_b128 v12, v[84:87] offset:1024
    ds_write_b128 v12, v[88:91] offset:2048
    ds_write_b128 v12, v[92:95] offset:3072
    s_waitcnt lgkmcnt(0)
L_conv_xchg:
    s_barrier
    ds_read_b128 v[80:83], v13 offset:0
    ds_read_b128 v[84:87], v13 offset:1024
    ds_read_b128 v[88:91], v13 offset:2048
    ds_read_b128 v[92:95], v13 offset:3072
    s_lshl_b32 s48, s38, 6
    v_lshlrev_b32 v14, 7, v3
    v_lshl_add_u32 v14, v4, 3, v14
    v_add_u32 v14, s48, v14
    s_lshl_b32 s49, s40, 12
    v_add_u32 v15, s49, v14
    s_add_u32 s49, s49, 4088
    v_sub_u32 v14, s49, v14
    v_subrev_u32 v5, 0, v14
    buffer_load_dwordx2 v[16:17], v5, s[12:15], 0 offen
    v_subrev_u32 v5, 16, v14
    buffer_load_dwordx2 v[18:19], v5, s[12:15], 0 offen
    v_subrev_u32 v5, 32, v14
    buffer_load_dwordx2 v[20:21], v5, s[12:15], 0 offen
    v_subrev_u32 v5, 48, v14
    buffer_load_dwordx2 v[22:23], v5, s[12:15], 0 offen
    v_lshlrev_b32 v10, 16, v10
    s_waitcnt lgkmcnt(0)
    v_add_f32 v64, v64, v80
    v_add_f32 v65, v65, v81
    v_add_f32 v66, v66, v82
    v_add_f32 v67, v67, v83
    v_add_f32 v68, v68, v84
    v_add_f32 v69, v69, v85
    v_add_f32 v70, v70, v86
    v_add_f32 v71, v71, v87
    v_add_f32 v72, v72, v88
    v_add_f32 v73, v73, v89
    v_add_f32 v74, v74, v90
    v_add_f32 v75, v75, v91
    v_add_f32 v76, v76, v92
    v_add_f32 v77, v77, v93
    v_add_f32 v78, v78, v94
    v_add_f32 v79, v79, v95
    s_waitcnt vmcnt(0)
    v_cvt_pk_bf16_f32 v24, v64, v65
    v_cvt_pk_bf16_f32 v25, v66, v67
    v_and_b32 v26, 0xffff0000, v17
    v_lshlrev_b32 v27, 16, v17
    v_and_b32 v28, 0xffff0000, v16
    v_lshlrev_b32 v29, 16, v16
    v_mul_f32 v26, v26, v10
    v_mul_f32 v27, v27, v10
    v_mul_f32 v28, v28, v10
    v_mul_f32 v29, v29, v10
    v_cvt_pk_bf16_f32 v26, v26, v27
    v_cvt_pk_bf16_f32 v28, v28, v29
    v_lshlrev_b32 v30, 16, v24
    v_and_b32 v31, 0xffff0000, v24
    v_lshlrev_b32 v32, 16, v25
    v_and_b32 v33, 0xffff0000, v25
    v_lshlrev_b32 v24, 16, v26
    v_and_b32 v25, 0xffff0000, v26
    v_lshlrev_b32 v26, 16, v28
    v_and_b32 v27, 0xffff0000, v28
    v_add_f32 v30, v30, v24
    v_add_f32 v31, v31, v25
    v_add_f32 v32, v32, v26
    v_add_f32 v33, v33, v27
    v_cvt_pk_bf16_f32 v30, v30, v31
    v_cvt_pk_bf16_f32 v31, v32, v33
    buffer_store_dwordx2 v[30:31], v15, s[16:19], 0 offen offset:0
    s_nop 1
    v_cvt_pk_bf16_f32 v24, v68, v69
    v_cvt_pk_bf16_f32 v25, v70, v71
    v_and_b32 v26, 0xffff0000, v19
    v_lshlrev_b32 v27, 16, v19
    v_and_b32 v28, 0xffff0000, v18
    v_lshlrev_b32 v29, 16, v18
    v_mul_f32 v26, v26, v10
    v_mul_f32 v27, v27, v10
    v_mul_f32 v28, v28, v10
    v_mul_f32 v29, v29, v10
    v_cvt_pk_bf16_f32 v26, v26, v27
    v_cvt_pk_bf16_f32 v28, v28, v29
    v_lshlrev_b32 v30, 16, v24
    v_and_b32 v31, 0xffff0000, v24
    v_lshlrev_b32 v32, 16, v25
    v_and_b32 v33, 0xffff0000, v25
    v_lshlrev_b32 v24, 16, v26
    v_and_b32 v25, 0xffff0000, v26
    v_lshlrev_b32 v26, 16, v28
    v_and_b32 v27, 0xffff0000, v28
    v_add_f32 v30, v30, v24
    v_add_f32 v31, v31, v25
    v_add_f32 v32, v32, v26
    v_add_f32 v33, v33, v27
    v_cvt_pk_bf16_f32 v30, v30, v31
    v_cvt_pk_bf16_f32 v31, v32, v33
    buffer_store_dwordx2 v[30:31], v15, s[16:19], 0 offen offset:16
    s_nop 1
    v_cvt_pk_bf16_f32 v24, v72, v73
    v_cvt_pk_bf16_f32 v25, v74, v75
    v_and_b32 v26, 0xffff0000, v21
    v_lshlrev_b32 v27, 16, v21
    v_and_b32 v28, 0xffff0000, v20
    v_lshlrev_b32 v29, 16, v20
    v_mul_f32 v26, v26, v10
    v_mul_f32 v27, v27, v10
    v_mul_f32 v28, v28, v10
    v_mul_f32 v29, v29, v10
    v_cvt_pk_bf16_f32 v26, v26, v27
    v_cvt_pk_bf16_f32 v28, v28, v29
    v_lshlrev_b32 v30, 16, v24
    v_and_b32 v31, 0xffff0000, v24
    v_lshlrev_b32 v32, 16, v25
    v_and_b32 v33, 0xffff0000, v25
    v_lshlrev_b32 v24, 16, v26
    v_and_b32 v25, 0xffff0000, v26
    v_lshlrev_b32 v26, 16, v28
    v_and_b32 v27, 0xffff0000, v28
    v_add_f32 v30, v30, v24
    v_add_f32 v31, v31, v25
    v_add_f32 v32, v32, v26
    v_add_f32 v33, v33, v27
    v_cvt_pk_bf16_f32 v30, v30, v31
    v_cvt_pk_bf16_f32 v31, v32, v33
    buffer_store_dwordx2 v[30:31], v15, s[16:19], 0 offen offset:32
    s_nop 1
    v_cvt_pk_bf16_f32 v24, v76, v77
    v_cvt_pk_bf16_f32 v25, v78, v79
    v_and_b32 v26, 0xffff0000, v23
    v_lshlrev_b32 v27, 16, v23
    v_and_b32 v28, 0xffff0000, v22
    v_lshlrev_b32 v29, 16, v22
    v_mul_f32 v26, v26, v10
    v_mul_f32 v27, v27, v10
    v_mul_f32 v28, v28, v10
    v_mul_f32 v29, v29, v10
    v_cvt_pk_bf16_f32 v26, v26, v27
    v_cvt_pk_bf16_f32 v28, v28, v29
    v_lshlrev_b32 v30, 16, v24
    v_and_b32 v31, 0xffff0000, v24
    v_lshlrev_b32 v32, 16, v25
    v_and_b32 v33, 0xffff0000, v25
    v_lshlrev_b32 v24, 16, v26
    v_and_b32 v25, 0xffff0000, v26
    v_lshlrev_b32 v26, 16, v28
    v_and_b32 v27, 0xffff0000, v28
    v_add_f32 v30, v30, v24
    v_add_f32 v31, v31, v25
    v_add_f32 v32, v32, v26
    v_add_f32 v33, v33, v27
    v_cvt_pk_bf16_f32 v30, v30, v31
    v_cvt_pk_bf16_f32 v31, v32, v33
    buffer_store_dwordx2 v[30:31], v15, s[16:19], 0 offen offset:48
    s_nop 1
    s_endpgm
L_mid_g1:
    s_sub_u32 s3, s2, 256
    s_load_dwordx2 s[4:5], s[0:1], 0
    s_load_dwordx2 s[6:7], s[0:1], 104
    s_load_dwordx2 s[24:25], s[0:1], 64
    s_and_b32 s26, s3, 15
    s_lshr_b32 s27, s3, 4
    v_lshrrev_b32 v1, 6, v0
    s_nop 0
    v_readfirstlane_b32 s28, v1
    s_mul_i32 s29, s27, 96
    s_lshl_b32 s30, s26, 7
    s_add_u32 s64, s29, 0
    s_lshl_b32 s64, s64, 10
    s_add_u32 s65, s29, 32
    s_lshl_b32 s65, s65, 10
    s_add_u32 s66, s29, 64
    s_lshl_b32 s66, s66, 10
    s_add_u32 s68, s30, 0
    s_lshl_b32 s68, s68, 10
    s_add_u32 s69, s30, 32
    s_lshl_b32 s69, s69, 10
    s_add_u32 s70, s30, 64
    s_lshl_b32 s70, s70, 10
    s_add_u32 s71, s30, 96
    s_lshl_b32 s71, s71, 10
    s_waitcnt lgkmcnt(0)
    s_add_u32 s8, s6, 0x200000
    s_addc_u32 s9, s7, 0
    s_mov_b32 s10, 0x158000
    s_mov_b32 s11, 0x00020000
    s_mov_b32 s12, s4
    s_mov_b32 s13, s5
    s_mov_b32 s14, 0x200000
    s_mov_b32 s15, 0x00020000
    s_mov_b32 s16, s24
    s_mov_b32 s17, s25
    s_mov_b32 s18, 0xac0
    s_mov_b32 s19, 0x00020000
    s_add_u32 s20, s6, 0x600000
    s_addc_u32 s21, s7, 0
    s_mov_b32 s22, 0x580000
    s_mov_b32 s23, 0x00020000
    v_and_b32 v12, 63, v0
    v_lshrrev_b32 v13, 6, v0
    v_lshrrev_b32 v14, 3, v12
    v_lshl_add_u32 v14, v13, 3, v14
    v_lshrrev_b32 v15, 4, v12
    v_lshl_add_u32 v15, v13, 2, v15
    v_xor_b32 v15, v15, v12
    v_and_b32 v15, 7, v15
    s_mov_b32 s60, 1024
    v_mul_lo_u32 v10, v14, s60
    v_lshl_add_u32 v10, v15, 4, v10
    s_mov_b32 s60, 1024
    v_mul_lo_u32 v11, v14, s60
    v_lshl_add_u32 v11, v15, 4, v11
    v_and_b32 v14, 31, v12
    v_lshrrev_b32 v15, 5, v12
    v_lshrrev_b32 v56, 1, v14
    v_and_b32 v56, 7, v56
    v_lshlrev_b32 v57, 7, v14
    v_add_u32 v58, 0, v15
    v_xor_b32 v58, v58, v56
    v_lshl_add_u32 v2, v58, 4, v57
    v_add_u32 v58, 2, v15
    v_xor_b32 v58, v58, v56
    v_lshl_add_u32 v3, v58, 4, v57
    v_add_u32 v58, 4, v15
    v_xor_b32 v58, v58, v56
    v_lshl_add_u32 v4, v58, 4, v57
    v_add_u32 v58, 6, v15
    v_xor_b32 v58, v58, v56
    v_lshl_add_u32 v5, v58, 4, v57
    v_lshlrev_b32 v58, 12, v13
    v_add_u32 v58, 12288, v58
    v_add_u32 v6, v2, v58
    v_add_u32 v7, v3, v58
    v_add_u32 v8, v4, v58
    v_add_u32 v9, v5, v58
    v_mov_b32 v64, 0
    v_mov_b32 v65, 0
    v_mov_b32 v66, 0
    v_mov_b32 v67, 0
    v_mov_b32 v68, 0
    v_mov_b32 v69, 0
    v_mov_b32 v70, 0
    v_mov_b32 v71, 0
    v_mov_b32 v72, 0
    v_mov_b32 v73, 0
    v_mov_b32 v74, 0
    v_mov_b32 v75, 0
    v_mov_b32 v76, 0
    v_mov_b32 v77, 0
    v_mov_b32 v78, 0
    v_mov_b32 v79, 0
    v_mov_b32 v80, 0
    v_mov_b32 v81, 0
    v_mov_b32 v82, 0
    v_mov_b32 v83, 0
    v_mov_b32 v84, 0
    v_mov_b32 v85, 0
    v_mov_b32 v86, 0
    v_mov_b32 v87, 0
    v_mov_b32 v88, 0
    v_mov_b32 v89, 0
    v_mov_b32 v90, 0
    v_mov_b32 v91, 0
    v_mov_b32 v92, 0
    v_mov_b32 v93, 0
    v_mov_b32 v94, 0
    v_mov_b32 v95, 0
    v_mov_b32 v96, 0
    v_mov_b32 v97, 0
    v_mov_b32 v98, 0
    v_mov_b32 v99, 0
    v_mov_b32 v100, 0
    v_mov_b32 v101, 0
    v_mov_b32 v102, 0
    v_mov_b32 v103, 0
    v_mov_b32 v104, 0
    v_mov_b32 v105, 0
    v_mov_b32 v106, 0
    v_mov_b32 v107, 0
    v_mov_b32 v108, 0
    v_mov_b32 v109, 0
    v_mov_b32 v110, 0
    v_mov_b32 v111, 0
    s_lshl_b32 s61, s28, 10
    s_add_u32 s62, s61, 0
    s_mov_b32 m0, s62
    buffer_load_dwordx4 v10, s[8:11], s64 offen lds
    s_add_u32 s62, s61, 4096
    s_mov_b32 m0, s62
    buffer_load_dwordx4 v10, s[8:11], s65 offen lds
    s_add_u32 s62, s61, 8192
    s_mov_b32 m0, s62
    buffer_load_dwordx4 v10, s[8:11], s66 offen lds
    s_add_u32 s62, s61, 12288
    s_mov_b32 m0, s62
    buffer_load_dwordx4 v11, s[12:15], s68 offen lds
    s_add_u32 s62, s61, 16384
    s_mov_b32 m0, s62
    buffer_load_dwordx4 v11, s[12:15], s69 offen lds
    s_add_u32 s62, s61, 20480
    s_mov_b32 m0, s62
    buffer_load_dwordx4 v11, s[12:15], s70 offen lds
    s_add_u32 s62, s61, 24576
    s_mov_b32 m0, s62
    buffer_load_dwordx4 v11, s[12:15], s71 offen lds
    v_add_u32 v10, 0x80, v10
    v_add_u32 v11, 0x80, v11
    s_waitcnt vmcnt(0)
    s_barrier
    s_add_u32 s62, s61, 28672
    s_mov_b32 m0, s62
    buffer_load_dwordx4 v10, s[8:11], s64 offen lds
    s_add_u32 s62, s61, 32768
    s_mov_b32 m0, s62
    buffer_load_dwordx4 v10, s[8:11], s65 offen lds
    s_add_u32 s62, s61, 36864
    s_mov_b32 m0, s62
    buffer_load_dwordx4 v10, s[8:11], s66 offen lds
    s_add_u32 s62, s61, 40960
    s_mov_b32 m0, s62
    buffer_load_dwordx4 v11, s[12:15], s68 offen lds
    s_add_u32 s62, s61, 45056
    s_mov_b32 m0, s62
    buffer_load_dwordx4 v11, s[12:15], s69 offen lds
    s_add_u32 s62, s61, 49152
    s_mov_b32 m0, s62
    buffer_load_dwordx4 v11, s[12:15], s70 offen lds
    s_add_u32 s62, s61, 53248
    s_mov_b32 m0, s62
    buffer_load_dwordx4 v11, s[12:15], s71 offen lds
    v_add_u32 v10, 0x80, v10
    v_add_u32 v11, 0x80, v11
    v_add_u32 v48, 0, v2
    v_add_u32 v49, 0, v6
    ds_read_b128 v[16:19], v48 offset:0
    ds_read_b128 v[20:23], v48 offset:4096
    ds_read_b128 v[24:27], v48 offset:8192
    ds_read_b128 v[28:31], v49
    v_add_u32 v48, 0, v3
    v_add_u32 v49, 0, v7
    ds_read_b128 v[32:35], v48 offset:0
    ds_read_b128 v[36:39], v48 offset:4096
    ds_read_b128 v[40:43], v48 offset:8192
    ds_read_b128 v[44:47], v49
    s_waitcnt lgkmcnt(4)
    v_mfma_f32_32x32x16_bf16 v[64:79], v[16:19], v[28:31], v[64:79]
    v_mfma_f32_32x32x16_bf16 v[80:95], v[20:23], v[28:31], v[80:95]
    v_mfma_f32_32x32x16_bf16 v[96:111], v[24:27], v[28:31], v[96:111]
    v_add_u32 v48, 0, v4
    v_add_u32 v49, 0, v8
    ds_read_b128 v[16:19], v48 offset:0
    ds_read_b128 v[20:23], v48 offset:4096
    ds_read_b128 v[24:27], v48 offset:8192
    ds_read_b128 v[28:31], v49
    s_waitcnt lgkmcnt(4)
    v_mfma_f32_32x32x16_bf16 v[64:79], v[32:35], v[44:47], v[64:79]
    v_mfma_f32_32x32x16_bf16 v[80:95], v[36:39], v[44:47], v[80:95]
    v_mfma_f32_32x32x16_bf16 v[96:111], v[40:43], v[44:47], v[96:111]
    v_add_u32 v48, 0, v5
    v_add_u32 v49, 0, v9
    ds_read_b128 v[32:35], v48 offset:0
    ds_read_b128 v[36:39], v48 offset:4096
    ds_read_b128 v[40:43], v48 offset:8192
    ds_read_b128 v[44:47], v49
    s_waitcnt lgkmcnt(4)
    v_mfma_f32_32x32x16_bf16 v[64:79], v[16:19], v[28:31], v[64:79]
    v_mfma_f32_32x32x16_bf16 v[80:95], v[20:23], v[28:31], v[80:95]
    v_mfma_f32_32x32x16_bf16 v[96:111], v[24:27], v[28:31], v[96:111]
    s_waitcnt lgkmcnt(0)
    v_mfma_f32_32x32x16_bf16 v[64:79], v[32:35], v[44:47], v[64:79]
    v_mfma_f32_32x32x16_bf16 v[80:95], v[36:39], v[44:47], v[80:95]
    v_mfma_f32_32x32x16_bf16 v[96:111], v[40:43], v[44:47], v[96:111]
    s_waitcnt vmcnt(0)
    s_barrier
    s_add_u32 s62, s61, 0
    s_mov_b32 m0, s62
    buffer_load_dwordx4 v10, s[8:11], s64 offen lds
    s_add_u32 s62, s61, 4096
    s_mov_b32 m0, s62
    buffer_load_dwordx4 v10, s[8:11], s65 offen lds
    s_add_u32 s62, s61, 8192
    s_mov_b32 m0, s62
    buffer_load_dwordx4 v10, s[8:11], s66 offen lds
    s_add_u32 s62, s61, 12288
    s_mov_b32 m0, s62
    buffer_load_dwordx4 v11, s[12:15], s68 offen lds
    s_add_u32 s62, s61, 16384
    s_mov_b32 m0, s62
    buffer_load_dwordx4 v11, s[12:15], s69 offen lds
    s_add_u32 s62, s61, 20480
    s_mov_b32 m0, s62
    buffer_load_dwordx4 v11, s[12:15], s70 offen lds
    s_add_u32 s62, s61, 24576
    s_mov_b32 m0, s62
    buffer_load_dwordx4 v11, s[12:15], s71 offen lds
    v_add_u32 v10, 0x80, v10
    v_add_u32 v11, 0x80, v11
    v_add_u32 v48, 28672, v2
    v_add_u32 v49, 28672, v6
    ds_read_b128 v[16:19], v48 offset:0
    ds_read_b128 v[20:23], v48 offset:4096
    ds_read_b128 v[24:27], v48 offset:8192
    ds_read_b128 v[28:31], v49
    v_add_u32 v48, 28672, v3
    v_add_u32 v49, 28672, v7
    ds_read_b128 v[32:35], v48 offset:0
    ds_read_b128 v[36:39], v48 offset:4096
    ds_read_b128 v[40:43], v48 offset:8192
    ds_read_b128 v[44:47], v49
    s_waitcnt lgkmcnt(4)
    v_mfma_f32_32x32x16_bf16 v[64:79], v[16:19], v[28:31], v[64:79]
    v_mfma_f32_32x32x16_bf16 v[80:95], v[20:23], v[28:31], v[80:95]
    v_mfma_f32_32x32x16_bf16 v[96:111], v[24:27], v[28:31], v[96:111]
    v_add_u32 v48, 28672, v4
    v_add_u32 v49, 28672, v8
    ds_read_b128 v[16:19], v48 offset:0
    ds_read_b128 v[20:23], v48 offset:4096
    ds_read_b128 v[24:27], v48 offset:8192
    ds_read_b128 v[28:31], v49
    s_waitcnt lgkmcnt(4)
    v_mfma_f32_32x32x16_bf16 v[64:79], v[32:35], v[44:47], v[64:79]
    v_mfma_f32_32x32x16_bf16 v[80:95], v[36:39], v[44:47], v[80:95]
    v_mfma_f32_32x32x16_bf16 v[96:111], v[40:43], v[44:47], v[96:111]
    v_add_u32 v48, 28672, v5
    v_add_u32 v49, 28672, v9
    ds_read_b128 v[32:35], v48 offset:0
    ds_read_b128 v[36:39], v48 offset:4096
    ds_read_b128 v[40:43], v48 offset:8192
    ds_read_b128 v[44:47], v49
    s_waitcnt lgkmcnt(4)
    v_mfma_f32_32x32x16_bf16 v[64:79], v[16:19], v[28:31], v[64:79]
    v_mfma_f32_32x32x16_bf16 v[80:95], v[20:23], v[28:31], v[80:95]
    v_mfma_f32_32x32x16_bf16 v[96:111], v[24:27], v[28:31], v[96:111]
    s_waitcnt lgkmcnt(0)
    v_mfma_f32_32x32x16_bf16 v[64:79], v[32:35], v[44:47], v[64:79]
    v_mfma_f32_32x32x16_bf16 v[80:95], v[36:39], v[44:47], v[80:95]
    v_mfma_f32_32x32x16_bf16 v[96:111], v[40:43], v[44:47], v[96:111]
    s_waitcnt vmcnt(0)
    s_barrier
    s_add_u32 s62, s61, 28672
    s_mov_b32 m0, s62
    buffer_load_dwordx4 v10, s[8:11], s64 offen lds
    s_add_u32 s62, s61, 32768
    s_mov_b32 m0, s62
    buffer_load_dwordx4 v10, s[8:11], s65 offen lds
    s_add_u32 s62, s61, 36864
    s_mov_b32 m0, s62
    buffer_load_dwordx4 v10, s[8:11], s66 offen lds
    s_add_u32 s62, s61, 40960
    s_mov_b32 m0, s62
    buffer_load_dwordx4 v11, s[12:15], s68 offen lds
    s_add_u32 s62, s61, 45056
    s_mov_b32 m0, s62
    buffer_load_dwordx4 v11, s[12:15], s69 offen lds
    s_add_u32 s62, s61, 49152
    s_mov_b32 m0, s62
    buffer_load_dwordx4 v11, s[12:15], s70 offen lds
    s_add_u32 s62, s61, 53248
    s_mov_b32 m0, s62
    buffer_load_dwordx4 v11, s[12:15], s71 offen lds
    v_add_u32 v10, 0x80, v10
    v_add_u32 v11, 0x80, v11
    v_add_u32 v48, 0, v2
    v_add_u32 v49, 0, v6
    ds_read_b128 v[16:19], v48 offset:0
    ds_read_b128 v[20:23], v48 offset:4096
    ds_read_b128 v[24:27], v48 offset:8192
    ds_read_b128 v[28:31], v49
    v_add_u32 v48, 0, v3
    v_add_u32 v49, 0, v7
    ds_read_b128 v[32:35], v48 offset:0
    ds_read_b128 v[36:39], v48 offset:4096
    ds_read_b128 v[40:43], v48 offset:8192
    ds_read_b128 v[44:47], v49
    s_waitcnt lgkmcnt(4)
    v_mfma_f32_32x32x16_bf16 v[64:79], v[16:19], v[28:31], v[64:79]
    v_mfma_f32_32x32x16_bf16 v[80:95], v[20:23], v[28:31], v[80:95]
    v_mfma_f32_32x32x16_bf16 v[96:111], v[24:27], v[28:31], v[96:111]
    v_add_u32 v48, 0, v4
    v_add_u32 v49, 0, v8
    ds_read_b128 v[16:19], v48 offset:0
    ds_read_b128 v[20:23], v48 offset:4096
    ds_read_b128 v[24:27], v48 offset:8192
    ds_read_b128 v[28:31], v49
    s_waitcnt lgkmcnt(4)
    v_mfma_f32_32x32x16_bf16 v[64:79], v[32:35], v[44:47], v[64:79]
    v_mfma_f32_32x32x16_bf16 v[80:95], v[36:39], v[44:47], v[80:95]
    v_mfma_f32_32x32x16_bf16 v[96:111], v[40:43], v[44:47], v[96:111]
    v_add_u32 v48, 0, v5
    v_add_u32 v49, 0, v9
    ds_read_b128 v[32:35], v48 offset:0
    ds_read_b128 v[36:39], v48 offset:4096
    ds_read_b128 v[40:43], v48 offset:8192
    ds_read_b128 v[44:47], v49
    s_waitcnt lgkmcnt(4)
    v_mfma_f32_32x32x16_bf16 v[64:79], v[16:19], v[28:31], v[64:79]
    v_mfma_f32_32x32x16_bf16 v[80:95], v[20:23], v[28:31], v[80:95]
    v_mfma_f32_32x32x16_bf16 v[96:111], v[24:27], v[28:31], v[96:111]
    s_waitcnt lgkmcnt(0)
    v_mfma_f32_32x32x16_bf16 v[64:79], v[32:35], v[44:47], v[64:79]
    v_mfma_f32_32x32x16_bf16 v[80:95], v[36:39], v[44:47], v[80:95]
    v_mfma_f32_32x32x16_bf16 v[96:111], v[40:43], v[44:47], v[96:111]
    s_waitcnt vmcnt(0)
    s_barrier
    s_add_u32 s62, s61, 0
    s_mov_b32 m0, s62
    buffer_load_dwordx4 v10, s[8:11], s64 offen lds
    s_add_u32 s62, s61, 4096
    s_mov_b32 m0, s62
    buffer_load_dwordx4 v10, s[8:11], s65 offen lds
    s_add_u32 s62, s61, 8192
    s_mov_b32 m0, s62
    buffer_load_dwordx4 v10, s[8:11], s66 offen lds
    s_add_u32 s62, s61, 12288
    s_mov_b32 m0, s62
    buffer_load_dwordx4 v11, s[12:15], s68 offen lds
    s_add_u32 s62, s61, 16384
    s_mov_b32 m0, s62
    buffer_load_dwordx4 v11, s[12:15], s69 offen lds
    s_add_u32 s62, s61, 20480
    s_mov_b32 m0, s62
    buffer_load_dwordx4 v11, s[12:15], s70 offen lds
    s_add_u32 s62, s61, 24576
    s_mov_b32 m0, s62
    buffer_load_dwordx4 v11, s[12:15], s71 offen lds
    v_add_u32 v10, 0x80, v10
    v_add_u32 v11, 0x80, v11
    v_add_u32 v48, 28672, v2
    v_add_u32 v49, 28672, v6
    ds_read_b128 v[16:19], v48 offset:0
    ds_read_b128 v[20:23], v48 offset:4096
    ds_read_b128 v[24:27], v48 offset:8192
    ds_read_b128 v[28:31], v49
    v_add_u32 v48, 28672, v3
    v_add_u32 v49, 28672, v7
    ds_read_b128 v[32:35], v48 offset:0
    ds_read_b128 v[36:39], v48 offset:4096
    ds_read_b128 v[40:43], v48 offset:8192
    ds_read_b128 v[44:47], v49
    s_waitcnt lgkmcnt(4)
    v_mfma_f32_32x32x16_bf16 v[64:79], v[16:19], v[28:31], v[64:79]
    v_mfma_f32_32x32x16_bf16 v[80:95], v[20:23], v[28:31], v[80:95]
    v_mfma_f32_32x32x16_bf16 v[96:111], v[24:27], v[28:31], v[96:111]
    v_add_u32 v48, 28672, v4
    v_add_u32 v49, 28672, v8
    ds_read_b128 v[16:19], v48 offset:0
    ds_read_b128 v[20:23], v48 offset:4096
    ds_read_b128 v[24:27], v48 offset:8192
    ds_read_b128 v[28:31], v49
    s_waitcnt lgkmcnt(4)
    v_mfma_f32_32x32x16_bf16 v[64:79], v[32:35], v[44:47], v[64:79]
    v_mfma_f32_32x32x16_bf16 v[80:95], v[36:39], v[44:47], v[80:95]
    v_mfma_f32_32x32x16_bf16 v[96:111], v[40:43], v[44:47], v[96:111]
    v_add_u32 v48, 28672, v5
    v_add_u32 v49, 28672, v9
    ds_read_b128 v[32:35], v48 offset:0
    ds_read_b128 v[36:39], v48 offset:4096
    ds_read_b128 v[40:43], v48 offset:8192
    ds_read_b128 v[44:47], v49
    s_waitcnt lgkmcnt(4)
    v_mfma_f32_32x32x16_bf16 v[64:79], v[16:19], v[28:31], v[64:79]
    v_mfma_f32_32x32x16_bf16 v[80:95], v[20:23], v[28:31], v[80:95]
    v_mfma_f32_32x32x16_bf16 v[96:111], v[24:27], v[28:31], v[96:111]
    s_waitcnt lgkmcnt(0)
    v_mfma_f32_32x32x16_bf16 v[64:79], v[32:35], v[44:47], v[64:79]
    v_mfma_f32_32x32x16_bf16 v[80:95], v[36:39], v[44:47], v[80:95]
    v_mfma_f32_32x32x16_bf16 v[96:111], v[40:43], v[44:47], v[96:111]
    s_waitcnt vmcnt(0)
    s_barrier
    s_add_u32 s62, s61, 28672
    s_mov_b32 m0, s62
    buffer_load_dwordx4 v10, s[8:11], s64 offen lds
    s_add_u32 s62, s61, 32768
    s_mov_b32 m0, s62
    buffer_load_dwordx4 v10, s[8:11], s65 offen lds
    s_add_u32 s62, s61, 36864
    s_mov_b32 m0, s62
    buffer_load_dwordx4 v10, s[8:11], s66 offen lds
    s_add_u32 s62, s61, 40960
    s_mov_b32 m0, s62
    buffer_load_dwordx4 v11, s[12:15], s68 offen lds
    s_add_u32 s62, s61, 45056
    s_mov_b32 m0, s62
    buffer_load_dwordx4 v11, s[12:15], s69 offen lds
    s_add_u32 s62, s61, 49152
    s_mov_b32 m0, s62
    buffer_load_dwordx4 v11, s[12:15], s70 offen lds
    s_add_u32 s62, s61, 53248
    s_mov_b32 m0, s62
    buffer_load_dwordx4 v11, s[12:15], s71 offen lds
    v_add_u32 v10, 0x80, v10
    v_add_u32 v11, 0x80, v11
    v_add_u32 v48, 0, v2
    v_add_u32 v49, 0, v6
    ds_read_b128 v[16:19], v48 offset:0
    ds_read_b128 v[20:23], v48 offset:4096
    ds_read_b128 v[24:27], v48 offset:8192
    ds_read_b128 v[28:31], v49
    v_add_u32 v48, 0, v3
    v_add_u32 v49, 0, v7
    ds_read_b128 v[32:35], v48 offset:0
    ds_read_b128 v[36:39], v48 offset:4096
    ds_read_b128 v[40:43], v48 offset:8192
    ds_read_b128 v[44:47], v49
    s_waitcnt lgkmcnt(4)
    v_mfma_f32_32x32x16_bf16 v[64:79], v[16:19], v[28:31], v[64:79]
    v_mfma_f32_32x32x16_bf16 v[80:95], v[20:23], v[28:31], v[80:95]
    v_mfma_f32_32x32x16_bf16 v[96:111], v[24:27], v[28:31], v[96:111]
    v_add_u32 v48, 0, v4
    v_add_u32 v49, 0, v8
    ds_read_b128 v[16:19], v48 offset:0
    ds_read_b128 v[20:23], v48 offset:4096
    ds_read_b128 v[24:27], v48 offset:8192
    ds_read_b128 v[28:31], v49
    s_waitcnt lgkmcnt(4)
    v_mfma_f32_32x32x16_bf16 v[64:79], v[32:35], v[44:47], v[64:79]
    v_mfma_f32_32x32x16_bf16 v[80:95], v[36:39], v[44:47], v[80:95]
    v_mfma_f32_32x32x16_bf16 v[96:111], v[40:43], v[44:47], v[96:111]
    v_add_u32 v48, 0, v5
    v_add_u32 v49, 0, v9
    ds_read_b128 v[32:35], v48 offset:0
    ds_read_b128 v[36:39], v48 offset:4096
    ds_read_b128 v[40:43], v48 offset:8192
    ds_read_b128 v[44:47], v49
    s_waitcnt lgkmcnt(4)
    v_mfma_f32_32x32x16_bf16 v[64:79], v[16:19], v[28:31], v[64:79]
    v_mfma_f32_32x32x16_bf16 v[80:95], v[20:23], v[28:31], v[80:95]
    v_mfma_f32_32x32x16_bf16 v[96:111], v[24:27], v[28:31], v[96:111]
    s_waitcnt lgkmcnt(0)
    v_mfma_f32_32x32x16_bf16 v[64:79], v[32:35], v[44:47], v[64:79]
    v_mfma_f32_32x32x16_bf16 v[80:95], v[36:39], v[44:47], v[80:95]
    v_mfma_f32_32x32x16_bf16 v[96:111], v[40:43], v[44:47], v[96:111]
    s_waitcnt vmcnt(0)
    s_barrier
    s_add_u32 s62, s61, 0
    s_mov_b32 m0, s62
    buffer_load_dwordx4 v10, s[8:11], s64 offen lds
    s_add_u32 s62, s61, 4096
    s_mov_b32 m0, s62
    buffer_load_dwordx4 v10, s[8:11], s65 offen lds
    s_add_u32 s62, s61, 8192
    s_mov_b32 m0, s62
    buffer_load_dwordx4 v10, s[8:11], s66 offen lds
    s_add_u32 s62, s61, 12288
    s_mov_b32 m0, s62
    buffer_load_dwordx4 v11, s[12:15], s68 offen lds
    s_add_u32 s62, s61, 16384
    s_mov_b32 m0, s62
    buffer_load_dwordx4 v11, s[12:15], s69 offen lds
    s_add_u32 s62, s61, 20480
    s_mov_b32 m0, s62
    buffer_load_dwordx4 v11, s[12:15], s70 offen lds
    s_add_u32 s62, s61, 24576
    s_mov_b32 m0, s62
    buffer_load_dwordx4 v11, s[12:15], s71 offen lds
    v_add_u32 v10, 0x80, v10
    v_add_u32 v11, 0x80, v11
    v_add_u32 v48, 28672, v2
    v_add_u32 v49, 28672, v6
    ds_read_b128 v[16:19], v48 offset:0
    ds_read_b128 v[20:23], v48 offset:4096
    ds_read_b128 v[24:27], v48 offset:8192
    ds_read_b128 v[28:31], v49
    v_add_u32 v48, 28672, v3
    v_add_u32 v49, 28672, v7
    ds_read_b128 v[32:35], v48 offset:0
    ds_read_b128 v[36:39], v48 offset:4096
    ds_read_b128 v[40:43], v48 offset:8192
    ds_read_b128 v[44:47], v49
    s_waitcnt lgkmcnt(4)
    v_mfma_f32_32x32x16_bf16 v[64:79], v[16:19], v[28:31], v[64:79]
    v_mfma_f32_32x32x16_bf16 v[80:95], v[20:23], v[28:31], v[80:95]
    v_mfma_f32_32x32x16_bf16 v[96:111], v[24:27], v[28:31], v[96:111]
    v_add_u32 v48, 28672, v4
    v_add_u32 v49, 28672, v8
    ds_read_b128 v[16:19], v48 offset:0
    ds_read_b128 v[20:23], v48 offset:4096
    ds_read_b128 v[24:27], v48 offset:8192
    ds_read_b128 v[28:31], v49
    s_waitcnt lgkmcnt(4)
    v_mfma_f32_32x32x16_bf16 v[64:79], v[32:35], v[44:47], v[64:79]
    v_mfma_f32_32x32x16_bf16 v[80:95], v[36:39], v[44:47], v[80:95]
    v_mfma_f32_32x32x16_bf16 v[96:111], v[40:43], v[44:47], v[96:111]
    v_add_u32 v48, 28672, v5
    v_add_u32 v49, 28672, v9
    ds_read_b128 v[32:35], v48 offset:0
    ds_read_b128 v[36:39], v48 offset:4096
    ds_read_b128 v[40:43], v48 offset:8192
    ds_read_b128 v[44:47], v49
    s_waitcnt lgkmcnt(4)
    v_mfma_f32_32x32x16_bf16 v[64:79], v[16:19], v[28:31], v[64:79]
    v_mfma_f32_32x32x16_bf16 v[80:95], v[20:23], v[28:31], v[80:95]
    v_mfma_f32_32x32x16_bf16 v[96:111], v[24:27], v[28:31], v[96:111]
    s_waitcnt lgkmcnt(0)
    v_mfma_f32_32x32x16_bf16 v[64:79], v[32:35], v[44:47], v[64:79]
    v_mfma_f32_32x32x16_bf16 v[80:95], v[36:39], v[44:47], v[80:95]
    v_mfma_f32_32x32x16_bf16 v[96:111], v[40:43], v[44:47], v[96:111]
    s_waitcnt vmcnt(0)
    s_barrier
    s_add_u32 s62, s61, 28672
    s_mov_b32 m0, s62
    buffer_load_dwordx4 v10, s[8:11], s64 offen lds
    s_add_u32 s62, s61, 32768
    s_mov_b32 m0, s62
    buffer_load_dwordx4 v10, s[8:11], s65 offen lds
    s_add_u32 s62, s61, 36864
    s_mov_b32 m0, s62
    buffer_load_dwordx4 v10, s[8:11], s66 offen lds
    s_add_u32 s62, s61, 40960
    s_mov_b32 m0, s62
    buffer_load_dwordx4 v11, s[12:15], s68 offen lds
    s_add_u32 s62, s61, 45056
    s_mov_b32 m0, s62
    buffer_load_dwordx4 v11, s[12:15], s69 offen lds
    s_add_u32 s62, s61, 49152
    s_mov_b32 m0, s62
    buffer_load_dwordx4 v11, s[12:15], s70 offen lds
    s_add_u32 s62, s61, 53248
    s_mov_b32 m0, s62
    buffer_load_dwordx4 v11, s[12:15], s71 offen lds
    v_add_u32 v10, 0x80, v10
    v_add_u32 v11, 0x80, v11
    v_add_u32 v48, 0, v2
    v_add_u32 v49, 0, v6
    ds_read_b128 v[16:19], v48 offset:0
    ds_read_b128 v[20:23], v48 offset:4096
    ds_read_b128 v[24:27], v48 offset:8192
    ds_read_b128 v[28:31], v49
    v_add_u32 v48, 0, v3
    v_add_u32 v49, 0, v7
    ds_read_b128 v[32:35], v48 offset:0
    ds_read_b128 v[36:39], v48 offset:4096
    ds_read_b128 v[40:43], v48 offset:8192
    ds_read_b128 v[44:47], v49
    s_waitcnt lgkmcnt(4)
    v_mfma_f32_32x32x16_bf16 v[64:79], v[16:19], v[28:31], v[64:79]
    v_mfma_f32_32x32x16_bf16 v[80:95], v[20:23], v[28:31], v[80:95]
    v_mfma_f32_32x32x16_bf16 v[96:111], v[24:27], v[28:31], v[96:111]
    v_add_u32 v48, 0, v4
    v_add_u32 v49, 0, v8
    ds_read_b128 v[16:19], v48 offset:0
    ds_read_b128 v[20:23], v48 offset:4096
    ds_read_b128 v[24:27], v48 offset:8192
    ds_read_b128 v[28:31], v49
    s_waitcnt lgkmcnt(4)
    v_mfma_f32_32x32x16_bf16 v[64:79], v[32:35], v[44:47], v[64:79]
    v_mfma_f32_32x32x16_bf16 v[80:95], v[36:39], v[44:47], v[80:95]
    v_mfma_f32_32x32x16_bf16 v[96:111], v[40:43], v[44:47], v[96:111]
    v_add_u32 v48, 0, v5
    v_add_u32 v49, 0, v9
    ds_read_b128 v[32:35], v48 offset:0
    ds_read_b128 v[36:39], v48 offset:4096
    ds_read_b128 v[40:43], v48 offset:8192
    ds_read_b128 v[44:47], v49
    s_waitcnt lgkmcnt(4)
    v_mfma_f32_32x32x16_bf16 v[64:79], v[16:19], v[28:31], v[64:79]
    v_mfma_f32_32x32x16_bf16 v[80:95], v[20:23], v[28:31], v[80:95]
    v_mfma_f32_32x32x16_bf16 v[96:111], v[24:27], v[28:31], v[96:111]
    s_waitcnt lgkmcnt(0)
    v_mfma_f32_32x32x16_bf16 v[64:79], v[32:35], v[44:47], v[64:79]
    v_mfma_f32_32x32x16_bf16 v[80:95], v[36:39], v[44:47], v[80:95]
    v_mfma_f32_32x32x16_bf16 v[96:111], v[40:43], v[44:47], v[96:111]
    s_waitcnt vmcnt(0)
    s_barrier
    v_add_u32 v48, 28672, v2
    v_add_u32 v49, 28672, v6
    ds_read_b128 v[16:19], v48 offset:0
    ds_read_b128 v[20:23], v48 offset:4096
    ds_read_b128 v[24:27], v48 offset:8192
    ds_read_b128 v[28:31], v49
    v_add_u32 v48, 28672, v3
    v_add_u32 v49, 28672, v7
    ds_read_b128 v[32:35], v48 offset:0
    ds_read_b128 v[36:39], v48 offset:4096
    ds_read_b128 v[40:43], v48 offset:8192
    ds_read_b128 v[44:47], v49
    s_waitcnt lgkmcnt(4)
    v_mfma_f32_32x32x16_bf16 v[64:79], v[16:19], v[28:31], v[64:79]
    v_mfma_f32_32x32x16_bf16 v[80:95], v[20:23], v[28:31], v[80:95]
    v_mfma_f32_32x32x16_bf16 v[96:111], v[24:27], v[28:31], v[96:111]
    v_add_u32 v48, 28672, v4
    v_add_u32 v49, 28672, v8
    ds_read_b128 v[16:19], v48 offset:0
    ds_read_b128 v[20:23], v48 offset:4096
    ds_read_b128 v[24:27], v48 offset:8192
    ds_read_b128 v[28:31], v49
    s_waitcnt lgkmcnt(4)
    v_mfma_f32_32x32x16_bf16 v[64:79], v[32:35], v[44:47], v[64:79]
    v_mfma_f32_32x32x16_bf16 v[80:95], v[36:39], v[44:47], v[80:95]
    v_mfma_f32_32x32x16_bf16 v[96:111], v[40:43], v[44:47], v[96:111]
    v_add_u32 v48, 28672, v5
    v_add_u32 v49, 28672, v9
    ds_read_b128 v[32:35], v48 offset:0
    ds_read_b128 v[36:39], v48 offset:4096
    ds_read_b128 v[40:43], v48 offset:8192
    ds_read_b128 v[44:47], v49
    s_waitcnt lgkmcnt(4)
    v_mfma_f32_32x32x16_bf16 v[64:79], v[16:19], v[28:31], v[64:79]
    v_mfma_f32_32x32x16_bf16 v[80:95], v[20:23], v[28:31], v[80:95]
    v_mfma_f32_32x32x16_bf16 v[96:111], v[24:27], v[28:31], v[96:111]
    s_waitcnt lgkmcnt(0)
    v_mfma_f32_32x32x16_bf16 v[64:79], v[32:35], v[44:47], v[64:79]
    v_mfma_f32_32x32x16_bf16 v[80:95], v[36:39], v[44:47], v[80:95]
    v_mfma_f32_32x32x16_bf16 v[96:111], v[40:43], v[44:47], v[96:111]
    v_and_b32 v14, 31, v12
    v_lshrrev_b32 v15, 5, v12
    v_lshl_add_u32 v14, v13, 5, v14
    v_add_u32 v14, s30, v14
    s_mov_b32 s60, 2816
    v_mul_lo_u32 v14, v14, s60
    s_lshl_b32 s31, s29, 1
    v_lshl_add_u32 v15, v15, 3, s31
    v_add_u32 v14, v14, v15
    buffer_load_dwordx2 v[16:17], v15, s[16:19], 0 offen offset:0
    buffer_load_dwordx2 v[18:19], v15, s[16:19], 0 offen offset:16
    buffer_load_dwordx2 v[20:21], v15, s[16:19], 0 offen offset:32
    buffer_load_dwordx2 v[22:23], v15, s[16:19], 0 offen offset:48
    buffer_load_dwordx2 v[24:25], v15, s[16:19], 0 offen offset:64
    buffer_load_dwordx2 v[26:27], v15, s[16:19], 0 offen offset:80
    buffer_load_dwordx2 v[28:29], v15, s[16:19], 0 offen offset:96
    buffer_load_dwordx2 v[30:31], v15, s[16:19], 0 offen offset:112
    buffer_load_dwordx2 v[32:33], v15, s[16:19], 0 offen offset:128
    buffer_load_dwordx2 v[34:35], v15, s[16:19], 0 offen offset:144
    buffer_load_dwordx2 v[36:37], v15, s[16:19], 0 offen offset:160
    buffer_load_dwordx2 v[38:39], v15, s[16:19], 0 offen offset:176
    s_waitcnt vmcnt(0)
    v_cvt_pk_bf16_f32 v40, v64, v65
    v_cvt_pk_bf16_f32 v41, v66, v67
    v_lshlrev_b32 v64, 16, v40
    v_and_b32 v65, 0xffff0000, v40
    v_lshlrev_b32 v66, 16, v41
    v_and_b32 v67, 0xffff0000, v41
    v_lshlrev_b32 v40, 16, v16
    v_and_b32 v41, 0xffff0000, v16
    v_lshlrev_b32 v42, 16, v17
    v_and_b32 v43, 0xffff0000, v17
    v_add_f32 v64, v64, v40
    v_add_f32 v65, v65, v41
    v_add_f32 v66, v66, v42
    v_add_f32 v67, v67, v43
    v_cvt_pk_bf16_f32 v40, v64, v65
    v_cvt_pk_bf16_f32 v41, v66, v67
    v_lshlrev_b32 v64, 16, v40
    v_and_b32 v65, 0xffff0000, v40
    v_lshlrev_b32 v66, 16, v41
    v_and_b32 v67, 0xffff0000, v41
    v_mul_f32 v40, 0x3fb8aa3b, v64
    v_mul_f32 v41, 0x3fb8aa3b, v65
    v_mul_f32 v42, 0x3fb8aa3b, v66
    v_mul_f32 v43, 0x3fb8aa3b, v67
    v_min_f32 v40, 0x42200000, v40
    v_min_f32 v41, 0x42200000, v41
    v_min_f32 v42, 0x42200000, v42
    v_min_f32 v43, 0x42200000, v43
    v_exp_f32 v40, v40
    v_exp_f32 v41, v41
    v_exp_f32 v42, v42
    v_exp_f32 v43, v43
    s_nop 0
    v_add_f32 v44, 2.0, v40
    v_add_f32 v45, 2.0, v41
    v_add_f32 v46, 2.0, v42
    v_add_f32 v47, 2.0, v43
    v_mul_f32 v40, v40, v44
    v_mul_f32 v41, v41, v45
    v_mul_f32 v42, v42, v46
    v_mul_f32 v43, v43, v47
    v_add_f32 v44, 2.0, v40
    v_add_f32 v45, 2.0, v41
    v_add_f32 v46, 2.0, v42
    v_add_f32 v47, 2.0, v43
    v_rcp_f32 v44, v44
    v_rcp_f32 v45, v45
    v_rcp_f32 v46, v46
    v_rcp_f32 v47, v47
    s_nop 0
    v_mul_f32 v40, v40, v44
    v_mul_f32 v41, v41, v45
    v_mul_f32 v42, v42, v46
    v_mul_f32 v43, v43, v47
    v_mul_f32 v40, v40, v64
    v_mul_f32 v41, v41, v65
    v_mul_f32 v42, v42, v66
    v_mul_f32 v43, v43, v67
    v_cvt_pk_bf16_f32 v2, v40, v41
    v_cvt_pk_bf16_f32 v3, v42, v43
    buffer_store_dwordx2 v[2:3], v14, s[20:23], 0 offen offset:0
    s_nop 1
    v_cvt_pk_bf16_f32 v40, v68, v69
    v_cvt_pk_bf16_f32 v41, v70, v71
    v_lshlrev_b32 v68, 16, v40
    v_and_b32 v69, 0xffff0000, v40
    v_lshlrev_b32 v70, 16, v41
    v_and_b32 v71, 0xffff0000, v41
    v_lshlrev_b32 v40, 16, v18
    v_and_b32 v41, 0xffff0000, v18
    v_lshlrev_b32 v42, 16, v19
    v_and_b32 v43, 0xffff0000, v19
    v_add_f32 v68, v68, v40
    v_add_f32 v69, v69, v41
    v_add_f32 v70, v70, v42
    v_add_f32 v71, v71, v43
    v_cvt_pk_bf16_f32 v40, v68, v69
    v_cvt_pk_bf16_f32 v41, v70, v71
    v_lshlrev_b32 v68, 16, v40
    v_and_b32 v69, 0xffff0000, v40
    v_lshlrev_b32 v70, 16, v41
    v_and_b32 v71, 0xffff0000, v41
    v_mul_f32 v40, 0x3fb8aa3b, v68
    v_mul_f32 v41, 0x3fb8aa3b, v69
    v_mul_f32 v42, 0x3fb8aa3b, v70
    v_mul_f32 v43, 0x3fb8aa3b, v71
    v_min_f32 v40, 0x42200000, v40
    v_min_f32 v41, 0x42200000, v41
    v_min_f32 v42, 0x42200000, v42
    v_min_f32 v43, 0x42200000, v43
    v_exp_f32 v40, v40
    v_exp_f32 v41, v41
    v_exp_f32 v42, v42
    v_exp_f32 v43, v43
    s_nop 0
    v_add_f32 v44, 2.0, v40
    v_add_f32 v45, 2.0, v41
    v_add_f32 v46, 2.0, v42
    v_add_f32 v47, 2.0, v43
    v_mul_f32 v40, v40, v44
    v_mul_f32 v41, v41, v45
    v_mul_f32 v42, v42, v46
    v_mul_f32 v43, v43, v47
    v_add_f32 v44, 2.0, v40
    v_add_f32 v45, 2.0, v41
    v_add_f32 v46, 2.0, v42
    v_add_f32 v47, 2.0, v43
    v_rcp_f32 v44, v44
    v_rcp_f32 v45, v45
    v_rcp_f32 v46, v46
    v_rcp_f32 v47, v47
    s_nop 0
    v_mul_f32 v40, v40, v44
    v_mul_f32 v41, v41, v45
    v_mul_f32 v42, v42, v46
    v_mul_f32 v43, v43, v47
    v_mul_f32 v40, v40, v68
    v_mul_f32 v41, v41, v69
    v_mul_f32 v42, v42, v70
    v_mul_f32 v43, v43, v71
    v_cvt_pk_bf16_f32 v2, v40, v41
    v_cvt_pk_bf16_f32 v3, v42, v43
    buffer_store_dwordx2 v[2:3], v14, s[20:23], 0 offen offset:16
    s_nop 1
    v_cvt_pk_bf16_f32 v40, v72, v73
    v_cvt_pk_bf16_f32 v41, v74, v75
    v_lshlrev_b32 v72, 16, v40
    v_and_b32 v73, 0xffff0000, v40
    v_lshlrev_b32 v74, 16, v41
    v_and_b32 v75, 0xffff0000, v41
    v_lshlrev_b32 v40, 16, v20
    v_and_b32 v41, 0xffff0000, v20
    v_lshlrev_b32 v42, 16, v21
    v_and_b32 v43, 0xffff0000, v21
    v_add_f32 v72, v72, v40
    v_add_f32 v73, v73, v41
    v_add_f32 v74, v74, v42
    v_add_f32 v75, v75, v43
    v_cvt_pk_bf16_f32 v40, v72, v73
    v_cvt_pk_bf16_f32 v41, v74, v75
    v_lshlrev_b32 v72, 16, v40
    v_and_b32 v73, 0xffff0000, v40
    v_lshlrev_b32 v74, 16, v41
    v_and_b32 v75, 0xffff0000, v41
    v_mul_f32 v40, 0x3fb8aa3b, v72
    v_mul_f32 v41, 0x3fb8aa3b, v73
    v_mul_f32 v42, 0x3fb8aa3b, v74
    v_mul_f32 v43, 0x3fb8aa3b, v75
    v_min_f32 v40, 0x42200000, v40
    v_min_f32 v41, 0x42200000, v41
    v_min_f32 v42, 0x42200000, v42
    v_min_f32 v43, 0x42200000, v43
    v_exp_f32 v40, v40
    v_exp_f32 v41, v41
    v_exp_f32 v42, v42
    v_exp_f32 v43, v43
    s_nop 0
    v_add_f32 v44, 2.0, v40
    v_add_f32 v45, 2.0, v41
    v_add_f32 v46, 2.0, v42
    v_add_f32 v47, 2.0, v43
    v_mul_f32 v40, v40, v44
    v_mul_f32 v41, v41, v45
    v_mul_f32 v42, v42, v46
    v_mul_f32 v43, v43, v47
    v_add_f32 v44, 2.0, v40
    v_add_f32 v45, 2.0, v41
    v_add_f32 v46, 2.0, v42
    v_add_f32 v47, 2.0, v43
    v_rcp_f32 v44, v44
    v_rcp_f32 v45, v45
    v_rcp_f32 v46, v46
    v_rcp_f32 v47, v47
    s_nop 0
    v_mul_f32 v40, v40, v44
    v_mul_f32 v41, v41, v45
    v_mul_f32 v42, v42, v46
    v_mul_f32 v43, v43, v47
    v_mul_f32 v40, v40, v72
    v_mul_f32 v41, v41, v73
    v_mul_f32 v42, v42, v74
    v_mul_f32 v43, v43, v75
    v_cvt_pk_bf16_f32 v2, v40, v41
    v_cvt_pk_bf16_f32 v3, v42, v43
    buffer_store_dwordx2 v[2:3], v14, s[20:23], 0 offen offset:32
    s_nop 1
    v_cvt_pk_bf16_f32 v40, v76, v77
    v_cvt_pk_bf16_f32 v41, v78, v79
    v_lshlrev_b32 v76, 16, v40
    v_and_b32 v77, 0xffff0000, v40
    v_lshlrev_b32 v78, 16, v41
    v_and_b32 v79, 0xffff0000, v41
    v_lshlrev_b32 v40, 16, v22
    v_and_b32 v41, 0xffff0000, v22
    v_lshlrev_b32 v42, 16, v23
    v_and_b32 v43, 0xffff0000, v23
    v_add_f32 v76, v76, v40
    v_add_f32 v77, v77, v41
    v_add_f32 v78, v78, v42
    v_add_f32 v79, v79, v43
    v_cvt_pk_bf16_f32 v40, v76, v77
    v_cvt_pk_bf16_f32 v41, v78, v79
    v_lshlrev_b32 v76, 16, v40
    v_and_b32 v77, 0xffff0000, v40
    v_lshlrev_b32 v78, 16, v41
    v_and_b32 v79, 0xffff0000, v41
    v_mul_f32 v40, 0x3fb8aa3b, v76
    v_mul_f32 v41, 0x3fb8aa3b, v77
    v_mul_f32 v42, 0x3fb8aa3b, v78
    v_mul_f32 v43, 0x3fb8aa3b, v79
    v_min_f32 v40, 0x42200000, v40
    v_min_f32 v41, 0x42200000, v41
    v_min_f32 v42, 0x42200000, v42
    v_min_f32 v43, 0x42200000, v43
    v_exp_f32 v40, v40
    v_exp_f32 v41, v41
    v_exp_f32 v42, v42
    v_exp_f32 v43, v43
    s_nop 0
    v_add_f32 v44, 2.0, v40
    v_add_f32 v45, 2.0, v41
    v_add_f32 v46, 2.0, v42
    v_add_f32 v47, 2.0, v43
    v_mul_f32 v40, v40, v44
    v_mul_f32 v41, v41, v45
    v_mul_f32 v42, v42, v46
    v_mul_f32 v43, v43, v47
    v_add_f32 v44, 2.0, v40
    v_add_f32 v45, 2.0, v41
    v_add_f32 v46, 2.0, v42
    v_add_f32 v47, 2.0, v43
    v_rcp_f32 v44, v44
    v_rcp_f32 v45, v45
    v_rcp_f32 v46, v46
    v_rcp_f32 v47, v47
    s_nop 0
    v_mul_f32 v40, v40, v44
    v_mul_f32 v41, v41, v45
    v_mul_f32 v42, v42, v46
    v_mul_f32 v43, v43, v47
    v_mul_f32 v40, v40, v76
    v_mul_f32 v41, v41, v77
    v_mul_f32 v42, v42, v78
    v_mul_f32 v43, v43, v79
    v_cvt_pk_bf16_f32 v2, v40, v41
    v_cvt_pk_bf16_f32 v3, v42, v43
    buffer_store_dwordx2 v[2:3], v14, s[20:23], 0 offen offset:48
    s_nop 1
    v_cvt_pk_bf16_f32 v40, v80, v81
    v_cvt_pk_bf16_f32 v41, v82, v83
    v_lshlrev_b32 v80, 16, v40
    v_and_b32 v81, 0xffff0000, v40
    v_lshlrev_b32 v82, 16, v41
    v_and_b32 v83, 0xffff0000, v41
    v_lshlrev_b32 v40, 16, v24
    v_and_b32 v41, 0xffff0000, v24
    v_lshlrev_b32 v42, 16, v25
    v_and_b32 v43, 0xffff0000, v25
    v_add_f32 v80, v80, v40
    v_add_f32 v81, v81, v41
    v_add_f32 v82, v82, v42
    v_add_f32 v83, v83, v43
    v_cvt_pk_bf16_f32 v40, v80, v81
    v_cvt_pk_bf16_f32 v41, v82, v83
    v_lshlrev_b32 v80, 16, v40
    v_and_b32 v81, 0xffff0000, v40
    v_lshlrev_b32 v82, 16, v41
    v_and_b32 v83, 0xffff0000, v41
    v_mul_f32 v40, 0x3fb8aa3b, v80
    v_mul_f32 v41, 0x3fb8aa3b, v81
    v_mul_f32 v42, 0x3fb8aa3b, v82
    v_mul_f32 v43, 0x3fb8aa3b, v83
    v_min_f32 v40, 0x42200000, v40
    v_min_f32 v41, 0x42200000, v41
    v_min_f32 v42, 0x42200000, v42
    v_min_f32 v43, 0x42200000, v43
    v_exp_f32 v40, v40
    v_exp_f32 v41, v41
    v_exp_f32 v42, v42
    v_exp_f32 v43, v43
    s_nop 0
    v_add_f32 v44, 2.0, v40
    v_add_f32 v45, 2.0, v41
    v_add_f32 v46, 2.0, v42
    v_add_f32 v47, 2.0, v43
    v_mul_f32 v40, v40, v44
    v_mul_f32 v41, v41, v45
    v_mul_f32 v42, v42, v46
    v_mul_f32 v43, v43, v47
    v_add_f32 v44, 2.0, v40
    v_add_f32 v45, 2.0, v41
    v_add_f32 v46, 2.0, v42
    v_add_f32 v47, 2.0, v43
    v_rcp_f32 v44, v44
    v_rcp_f32 v45, v45
    v_rcp_f32 v46, v46
    v_rcp_f32 v47, v47
    s_nop 0
    v_mul_f32 v40, v40, v44
    v_mul_f32 v41, v41, v45
    v_mul_f32 v42, v42, v46
    v_mul_f32 v43, v43, v47
    v_mul_f32 v40, v40, v80
    v_mul_f32 v41, v41, v81
    v_mul_f32 v42, v42, v82
    v_mul_f32 v43, v43, v83
    v_cvt_pk_bf16_f32 v2, v40, v41
    v_cvt_pk_bf16_f32 v3, v42, v43
    buffer_store_dwordx2 v[2:3], v14, s[20:23], 0 offen offset:64
    s_nop 1
    v_cvt_pk_bf16_f32 v40, v84, v85
    v_cvt_pk_bf16_f32 v41, v86, v87
    v_lshlrev_b32 v84, 16, v40
    v_and_b32 v85, 0xffff0000, v40
    v_lshlrev_b32 v86, 16, v41
    v_and_b32 v87, 0xffff0000, v41
    v_lshlrev_b32 v40, 16, v26
    v_and_b32 v41, 0xffff0000, v26
    v_lshlrev_b32 v42, 16, v27
    v_and_b32 v43, 0xffff0000, v27
    v_add_f32 v84, v84, v40
    v_add_f32 v85, v85, v41
    v_add_f32 v86, v86, v42
    v_add_f32 v87, v87, v43
    v_cvt_pk_bf16_f32 v40, v84, v85
    v_cvt_pk_bf16_f32 v41, v86, v87
    v_lshlrev_b32 v84, 16, v40
    v_and_b32 v85, 0xffff0000, v40
    v_lshlrev_b32 v86, 16, v41
    v_and_b32 v87, 0xffff0000, v41
    v_mul_f32 v40, 0x3fb8aa3b, v84
    v_mul_f32 v41, 0x3fb8aa3b, v85
    v_mul_f32 v42, 0x3fb8aa3b, v86
    v_mul_f32 v43, 0x3fb8aa3b, v87
    v_min_f32 v40, 0x42200000, v40
    v_min_f32 v41, 0x42200000, v41
    v_min_f32 v42, 0x42200000, v42
    v_min_f32 v43, 0x42200000, v43
    v_exp_f32 v40, v40
    v_exp_f32 v41, v41
    v_exp_f32 v42, v42
    v_exp_f32 v43, v43
    s_nop 0
    v_add_f32 v44, 2.0, v40
    v_add_f32 v45, 2.0, v41
    v_add_f32 v46, 2.0, v42
    v_add_f32 v47, 2.0, v43
    v_mul_f32 v40, v40, v44
    v_mul_f32 v41, v41, v45
    v_mul_f32 v42, v42, v46
    v_mul_f32 v43, v43, v47
    v_add_f32 v44, 2.0, v40
    v_add_f32 v45, 2.0, v41
    v_add_f32 v46, 2.0, v42
    v_add_f32 v47, 2.0, v43
    v_rcp_f32 v44, v44
    v_rcp_f32 v45, v45
    v_rcp_f32 v46, v46
    v_rcp_f32 v47, v47
    s_nop 0
    v_mul_f32 v40, v40, v44
    v_mul_f32 v41, v41, v45
    v_mul_f32 v42, v42, v46
    v_mul_f32 v43, v43, v47
    v_mul_f32 v40, v40, v84
    v_mul_f32 v41, v41, v85
    v_mul_f32 v42, v42, v86
    v_mul_f32 v43, v43, v87
    v_cvt_pk_bf16_f32 v2, v40, v41
    v_cvt_pk_bf16_f32 v3, v42, v43
    buffer_store_dwordx2 v[2:3], v14, s[20:23], 0 offen offset:80
    s_nop 1
    v_cvt_pk_bf16_f32 v40, v88, v89
    v_cvt_pk_bf16_f32 v41, v90, v91
    v_lshlrev_b32 v88, 16, v40
    v_and_b32 v89, 0xffff0000, v40
    v_lshlrev_b32 v90, 16, v41
    v_and_b32 v91, 0xffff0000, v41
    v_lshlrev_b32 v40, 16, v28
    v_and_b32 v41, 0xffff0000, v28
    v_lshlrev_b32 v42, 16, v29
    v_and_b32 v43, 0xffff0000, v29
    v_add_f32 v88, v88, v40
    v_add_f32 v89, v89, v41
    v_add_f32 v90, v90, v42
    v_add_f32 v91, v91, v43
    v_cvt_pk_bf16_f32 v40, v88, v89
    v_cvt_pk_bf16_f32 v41, v90, v91
    v_lshlrev_b32 v88, 16, v40
    v_and_b32 v89, 0xffff0000, v40
    v_lshlrev_b32 v90, 16, v41
    v_and_b32 v91, 0xffff0000, v41
    v_mul_f32 v40, 0x3fb8aa3b, v88
    v_mul_f32 v41, 0x3fb8aa3b, v89
    v_mul_f32 v42, 0x3fb8aa3b, v90
    v_mul_f32 v43, 0x3fb8aa3b, v91
    v_min_f32 v40, 0x42200000, v40
    v_min_f32 v41, 0x42200000, v41
    v_min_f32 v42, 0x42200000, v42
    v_min_f32 v43, 0x42200000, v43
    v_exp_f32 v40, v40
    v_exp_f32 v41, v41
    v_exp_f32 v42, v42
    v_exp_f32 v43, v43
    s_nop 0
    v_add_f32 v44, 2.0, v40
    v_add_f32 v45, 2.0, v41
    v_add_f32 v46, 2.0, v42
    v_add_f32 v47, 2.0, v43
    v_mul_f32 v40, v40, v44
    v_mul_f32 v41, v41, v45
    v_mul_f32 v42, v42, v46
    v_mul_f32 v43, v43, v47
    v_add_f32 v44, 2.0, v40
    v_add_f32 v45, 2.0, v41
    v_add_f32 v46, 2.0, v42
    v_add_f32 v47, 2.0, v43
    v_rcp_f32 v44, v44
    v_rcp_f32 v45, v45
    v_rcp_f32 v46, v46
    v_rcp_f32 v47, v47
    s_nop 0
    v_mul_f32 v40, v40, v44
    v_mul_f32 v41, v41, v45
    v_mul_f32 v42, v42, v46
    v_mul_f32 v43, v43, v47
    v_mul_f32 v40, v40, v88
    v_mul_f32 v41, v41, v89
    v_mul_f32 v42, v42, v90
    v_mul_f32 v43, v43, v91
    v_cvt_pk_bf16_f32 v2, v40, v41
    v_cvt_pk_bf16_f32 v3, v42, v43
    buffer_store_dwordx2 v[2:3], v14, s[20:23], 0 offen offset:96
    s_nop 1
    v_cvt_pk_bf16_f32 v40, v92, v93
    v_cvt_pk_bf16_f32 v41, v94, v95
    v_lshlrev_b32 v92, 16, v40
    v_and_b32 v93, 0xffff0000, v40
    v_lshlrev_b32 v94, 16, v41
    v_and_b32 v95, 0xffff0000, v41
    v_lshlrev_b32 v40, 16, v30
    v_and_b32 v41, 0xffff0000, v30
    v_lshlrev_b32 v42, 16, v31
    v_and_b32 v43, 0xffff0000, v31
    v_add_f32 v92, v92, v40
    v_add_f32 v93, v93, v41
    v_add_f32 v94, v94, v42
    v_add_f32 v95, v95, v43
    v_cvt_pk_bf16_f32 v40, v92, v93
    v_cvt_pk_bf16_f32 v41, v94, v95
    v_lshlrev_b32 v92, 16, v40
    v_and_b32 v93, 0xffff0000, v40
    v_lshlrev_b32 v94, 16, v41
    v_and_b32 v95, 0xffff0000, v41
    v_mul_f32 v40, 0x3fb8aa3b, v92
    v_mul_f32 v41, 0x3fb8aa3b, v93
    v_mul_f32 v42, 0x3fb8aa3b, v94
    v_mul_f32 v43, 0x3fb8aa3b, v95
    v_min_f32 v40, 0x42200000, v40
    v_min_f32 v41, 0x42200000, v41
    v_min_f32 v42, 0x42200000, v42
    v_min_f32 v43, 0x42200000, v43
    v_exp_f32 v40, v40
    v_exp_f32 v41, v41
    v_exp_f32 v42, v42
    v_exp_f32 v43, v43
    s_nop 0
    v_add_f32 v44, 2.0, v40
    v_add_f32 v45, 2.0, v41
    v_add_f32 v46, 2.0, v42
    v_add_f32 v47, 2.0, v43
    v_mul_f32 v40, v40, v44
    v_mul_f32 v41, v41, v45
    v_mul_f32 v42, v42, v46
    v_mul_f32 v43, v43, v47
    v_add_f32 v44, 2.0, v40
    v_add_f32 v45, 2.0, v41
    v_add_f32 v46, 2.0, v42
    v_add_f32 v47, 2.0, v43
    v_rcp_f32 v44, v44
    v_rcp_f32 v45, v45
    v_rcp_f32 v46, v46
    v_rcp_f32 v47, v47
    s_nop 0
    v_mul_f32 v40, v40, v44
    v_mul_f32 v41, v41, v45
    v_mul_f32 v42, v42, v46
    v_mul_f32 v43, v43, v47
    v_mul_f32 v40, v40, v92
    v_mul_f32 v41, v41, v93
    v_mul_f32 v42, v42, v94
    v_mul_f32 v43, v43, v95
    v_cvt_pk_bf16_f32 v2, v40, v41
    v_cvt_pk_bf16_f32 v3, v42, v43
    buffer_store_dwordx2 v[2:3], v14, s[20:23], 0 offen offset:112
    s_nop 1
    s_cmp_eq_u32 s27, 14
    s_cbranch_scc1 L_g1_done
    v_cvt_pk_bf16_f32 v40, v96, v97
    v_cvt_pk_bf16_f32 v41, v98, v99
    v_lshlrev_b32 v96, 16, v40
    v_and_b32 v97, 0xffff0000, v40
    v_lshlrev_b32 v98, 16, v41
    v_and_b32 v99, 0xffff0000, v41
    v_lshlrev_b32 v40, 16, v32
    v_and_b32 v41, 0xffff0000, v32
    v_lshlrev_b32 v42, 16, v33
    v_and_b32 v43, 0xffff0000, v33
    v_add_f32 v96, v96, v40
    v_add_f32 v97, v97, v41
    v_add_f32 v98, v98, v42
    v_add_f32 v99, v99, v43
    v_cvt_pk_bf16_f32 v40, v96, v97
    v_cvt_pk_bf16_f32 v41, v98, v99
    v_lshlrev_b32 v96, 16, v40
    v_and_b32 v97, 0xffff0000, v40
    v_lshlrev_b32 v98, 16, v41
    v_and_b32 v99, 0xffff0000, v41
    v_mul_f32 v40, 0x3fb8aa3b, v96
    v_mul_f32 v41, 0x3fb8aa3b, v97
    v_mul_f32 v42, 0x3fb8aa3b, v98
    v_mul_f32 v43, 0x3fb8aa3b, v99
    v_min_f32 v40, 0x42200000, v40
    v_min_f32 v41, 0x42200000, v41
    v_min_f32 v42, 0x42200000, v42
    v_min_f32 v43, 0x42200000, v43
    v_exp_f32 v40, v40
    v_exp_f32 v41, v41
    v_exp_f32 v42, v42
    v_exp_f32 v43, v43
    s_nop 0
    v_add_f32 v44, 2.0, v40
    v_add_f32 v45, 2.0, v41
    v_add_f32 v46, 2.0, v42
    v_add_f32 v47, 2.0, v43
    v_mul_f32 v40, v40, v44
    v_mul_f32 v41, v41, v45
    v_mul_f32 v42, v42, v46
    v_mul_f32 v43, v43, v47
    v_add_f32 v44, 2.0, v40
    v_add_f32 v45, 2.0, v41
    v_add_f32 v46, 2.0, v42
    v_add_f32 v47, 2.0, v43
    v_rcp_f32 v44, v44
    v_rcp_f32 v45, v45
    v_rcp_f32 v46, v46
    v_rcp_f32 v47, v47
    s_nop 0
    v_mul_f32 v40, v40, v44
    v_mul_f32 v41, v41, v45
    v_mul_f32 v42, v42, v46
    v_mul_f32 v43, v43, v47
    v_mul_f32 v40, v40, v96
    v_mul_f32 v41, v41, v97
    v_mul_f32 v42, v42, v98
    v_mul_f32 v43, v43, v99
    v_cvt_pk_bf16_f32 v2, v40, v41
    v_cvt_pk_bf16_f32 v3, v42, v43
    buffer_store_dwordx2 v[2:3], v14, s[20:23], 0 offen offset:128
    s_nop 1
    v_cvt_pk_bf16_f32 v40, v100, v101
    v_cvt_pk_bf16_f32 v41, v102, v103
    v_lshlrev_b32 v100, 16, v40
    v_and_b32 v101, 0xffff0000, v40
    v_lshlrev_b32 v102, 16, v41
    v_and_b32 v103, 0xffff0000, v41
    v_lshlrev_b32 v40, 16, v34
    v_and_b32 v41, 0xffff0000, v34
    v_lshlrev_b32 v42, 16, v35
    v_and_b32 v43, 0xffff0000, v35
    v_add_f32 v100, v100, v40
    v_add_f32 v101, v101, v41
    v_add_f32 v102, v102, v42
    v_add_f32 v103, v103, v43
    v_cvt_pk_bf16_f32 v40, v100, v101
    v_cvt_pk_bf16_f32 v41, v102, v103
    v_lshlrev_b32 v100, 16, v40
    v_and_b32 v101, 0xffff0000, v40
    v_lshlrev_b32 v102, 16, v41
    v_and_b32 v103, 0xffff0000, v41
    v_mul_f32 v40, 0x3fb8aa3b, v100
    v_mul_f32 v41, 0x3fb8aa3b, v101
    v_mul_f32 v42, 0x3fb8aa3b, v102
    v_mul_f32 v43, 0x3fb8aa3b, v103
    v_min_f32 v40, 0x42200000, v40
    v_min_f32 v41, 0x42200000, v41
    v_min_f32 v42, 0x42200000, v42
    v_min_f32 v43, 0x42200000, v43
    v_exp_f32 v40, v40
    v_exp_f32 v41, v41
    v_exp_f32 v42, v42
    v_exp_f32 v43, v43
    s_nop 0
    v_add_f32 v44, 2.0, v40
    v_add_f32 v45, 2.0, v41
    v_add_f32 v46, 2.0, v42
    v_add_f32 v47, 2.0, v43
    v_mul_f32 v40, v40, v44
    v_mul_f32 v41, v41, v45
    v_mul_f32 v42, v42, v46
    v_mul_f32 v43, v43, v47
    v_add_f32 v44, 2.0, v40
    v_add_f32 v45, 2.0, v41
    v_add_f32 v46, 2.0, v42
    v_add_f32 v47, 2.0, v43
    v_rcp_f32 v44, v44
    v_rcp_f32 v45, v45
    v_rcp_f32 v46, v46
    v_rcp_f32 v47, v47
    s_nop 0
    v_mul_f32 v40, v40, v44
    v_mul_f32 v41, v41, v45
    v_mul_f32 v42, v42, v46
    v_mul_f32 v43, v43, v47
    v_mul_f32 v40, v40, v100
    v_mul_f32 v41, v41, v101
    v_mul_f32 v42, v42, v102
    v_mul_f32 v43, v43, v103
    v_cvt_pk_bf16_f32 v2, v40, v41
    v_cvt_pk_bf16_f32 v3, v42, v43
    buffer_store_dwordx2 v[2:3], v14, s[20:23], 0 offen offset:144
    s_nop 1
    v_cvt_pk_bf16_f32 v40, v104, v105
    v_cvt_pk_bf16_f32 v41, v106, v107
    v_lshlrev_b32 v104, 16, v40
    v_and_b32 v105, 0xffff0000, v40
    v_lshlrev_b32 v106, 16, v41
    v_and_b32 v107, 0xffff0000, v41
    v_lshlrev_b32 v40, 16, v36
    v_and_b32 v41, 0xffff0000, v36
    v_lshlrev_b32 v42, 16, v37
    v_and_b32 v43, 0xffff0000, v37
    v_add_f32 v104, v104, v40
    v_add_f32 v105, v105, v41
    v_add_f32 v106, v106, v42
    v_add_f32 v107, v107, v43
    v_cvt_pk_bf16_f32 v40, v104, v105
    v_cvt_pk_bf16_f32 v41, v106, v107
    v_lshlrev_b32 v104, 16, v40
    v_and_b32 v105, 0xffff0000, v40
    v_lshlrev_b32 v106, 16, v41
    v_and_b32 v107, 0xffff0000, v41
    v_mul_f32 v40, 0x3fb8aa3b, v104
    v_mul_f32 v41, 0x3fb8aa3b, v105
    v_mul_f32 v42, 0x3fb8aa3b, v106
    v_mul_f32 v43, 0x3fb8aa3b, v107
    v_min_f32 v40, 0x42200000, v40
    v_min_f32 v41, 0x42200000, v41
    v_min_f32 v42, 0x42200000, v42
    v_min_f32 v43, 0x42200000, v43
    v_exp_f32 v40, v40
    v_exp_f32 v41, v41
    v_exp_f32 v42, v42
    v_exp_f32 v43, v43
    s_nop 0
    v_add_f32 v44, 2.0, v40
    v_add_f32 v45, 2.0, v41
    v_add_f32 v46, 2.0, v42
    v_add_f32 v47, 2.0, v43
    v_mul_f32 v40, v40, v44
    v_mul_f32 v41, v41, v45
    v_mul_f32 v42, v42, v46
    v_mul_f32 v43, v43, v47
    v_add_f32 v44, 2.0, v40
    v_add_f32 v45, 2.0, v41
    v_add_f32 v46, 2.0, v42
    v_add_f32 v47, 2.0, v43
    v_rcp_f32 v44, v44
    v_rcp_f32 v45, v45
    v_rcp_f32 v46, v46
    v_rcp_f32 v47, v47
    s_nop 0
    v_mul_f32 v40, v40, v44
    v_mul_f32 v41, v41, v45
    v_mul_f32 v42, v42, v46
    v_mul_f32 v43, v43, v47
    v_mul_f32 v40, v40, v104
    v_mul_f32 v41, v41, v105
    v_mul_f32 v42, v42, v106
    v_mul_f32 v43, v43, v107
    v_cvt_pk_bf16_f32 v2, v40, v41
    v_cvt_pk_bf16_f32 v3, v42, v43
    buffer_store_dwordx2 v[2:3], v14, s[20:23], 0 offen offset:160
    s_nop 1
    v_cvt_pk_bf16_f32 v40, v108, v109
    v_cvt_pk_bf16_f32 v41, v110, v111
    v_lshlrev_b32 v108, 16, v40
    v_and_b32 v109, 0xffff0000, v40
    v_lshlrev_b32 v110, 16, v41
    v_and_b32 v111, 0xffff0000, v41
    v_lshlrev_b32 v40, 16, v38
    v_and_b32 v41, 0xffff0000, v38
    v_lshlrev_b32 v42, 16, v39
    v_and_b32 v43, 0xffff0000, v39
    v_add_f32 v108, v108, v40
    v_add_f32 v109, v109, v41
    v_add_f32 v110, v110, v42
    v_add_f32 v111, v111, v43
    v_cvt_pk_bf16_f32 v40, v108, v109
    v_cvt_pk_bf16_f32 v41, v110, v111
    v_lshlrev_b32 v108, 16, v40
    v_and_b32 v109, 0xffff0000, v40
    v_lshlrev_b32 v110, 16, v41
    v_and_b32 v111, 0xffff0000, v41
    v_mul_f32 v40, 0x3fb8aa3b, v108
    v_mul_f32 v41, 0x3fb8aa3b, v109
    v_mul_f32 v42, 0x3fb8aa3b, v110
    v_mul_f32 v43, 0x3fb8aa3b, v111
    v_min_f32 v40, 0x42200000, v40
    v_min_f32 v41, 0x42200000, v41
    v_min_f32 v42, 0x42200000, v42
    v_min_f32 v43, 0x42200000, v43
    v_exp_f32 v40, v40
    v_exp_f32 v41, v41
    v_exp_f32 v42, v42
    v_exp_f32 v43, v43
    s_nop 0
    v_add_f32 v44, 2.0, v40
    v_add_f32 v45, 2.0, v41
    v_add_f32 v46, 2.0, v42
    v_add_f32 v47, 2.0, v43
    v_mul_f32 v40, v40, v44
    v_mul_f32 v41, v41, v45
    v_mul_f32 v42, v42, v46
    v_mul_f32 v43, v43, v47
    v_add_f32 v44, 2.0, v40
    v_add_f32 v45, 2.0, v41
    v_add_f32 v46, 2.0, v42
    v_add_f32 v47, 2.0, v43
    v_rcp_f32 v44, v44
    v_rcp_f32 v45, v45
    v_rcp_f32 v46, v46
    v_rcp_f32 v47, v47
    s_nop 0
    v_mul_f32 v40, v40, v44
    v_mul_f32 v41, v41, v45
    v_mul_f32 v42, v42, v46
    v_mul_f32 v43, v43, v47
    v_mul_f32 v40, v40, v108
    v_mul_f32 v41, v41, v109
    v_mul_f32 v42, v42, v110
    v_mul_f32 v43, v43, v111
    v_cvt_pk_bf16_f32 v2, v40, v41
    v_cvt_pk_bf16_f32 v3, v42, v43
    buffer_store_dwordx2 v[2:3], v14, s[20:23], 0 offen offset:176
    s_nop 1
L_g1_done:
    s_endpgm
L_mid_exit:
    s_endpgm
.globl gemm2_kernel
.p2align 8
.type gemm2_kernel,@function
gemm2_kernel:
    s_cmp_ge_u32 s2, 256
    s_cbranch_scc1 L_g2_exit
    s_load_dwordx2 s[4:5], s[0:1], 0
    s_load_dwordx2 s[6:7], s[0:1], 104
    s_load_dwordx2 s[24:25], s[0:1], 88
    s_and_b32 s26, s2, 31
    s_lshr_b32 s27, s2, 5
    v_lshrrev_b32 v1, 6, v0
    s_nop 0
    v_readfirstlane_b32 s28, v1
    s_lshl_b32 s29, s27, 6
    s_lshl_b32 s30, s26, 6
    s_mov_b32 s60, 2816
    s_add_u32 s64, s29, 0
    s_mul_i32 s64, s64, s60
    s_add_u32 s68, s30, 0
    s_mul_i32 s68, s68, s60
    s_add_u32 s65, s29, 32
    s_mul_i32 s65, s65, s60
    s_add_u32 s69, s30, 32
    s_mul_i32 s69, s69, s60
    s_waitcnt lgkmcnt(0)
    s_add_u32 s8, s6, 0x400000
    s_addc_u32 s9, s7, 0
    s_mov_b32 s10, 0x160000
    s_mov_b32 s11, 0x00020000
    s_add_u32 s12, s6, 0x600000
    s_addc_u32 s13, s7, 0
    s_mov_b32 s14, 0x580000
    s_mov_b32 s15, 0x00020000
    s_add_u32 s16, s6, 0xc00000
    s_addc_u32 s17, s7, 0
    s_mov_b32 s18, 0x200000
    s_mov_b32 s19, 0x00020000
    s_mov_b32 s20, s4
    s_mov_b32 s21, s5
    s_mov_b32 s22, 0x200000
    s_mov_b32 s23, 0x00020000
    s_mov_b32 s72, s24
    s_mov_b32 s73, s25
    s_mov_b32 s74, 0x200000
    s_mov_b32 s75, 0x00020000
    s_add_u32 s76, s6, 0xe00000
    s_addc_u32 s77, s7, 0
    s_mov_b32 s78, 0x2000
    s_mov_b32 s79, 0x00020000
    v_and_b32 v12, 63, v0
    v_lshrrev_b32 v13, 6, v0
    v_lshrrev_b32 v14, 3, v12
    v_lshl_add_u32 v14, v13, 3, v14
    v_lshrrev_b32 v15, 4, v12
    v_lshl_add_u32 v15, v13, 2, v15
    v_xor_b32 v15, v15, v12
    v_and_b32 v15, 7, v15
    s_mov_b32 s60, 2816
    v_mul_lo_u32 v10, v14, s60
    v_lshl_add_u32 v10, v15, 4, v10
    s_mov_b32 s60, 2816
    v_mul_lo_u32 v11, v14, s60
    v_lshl_add_u32 v11, v15, 4, v11
    v_and_b32 v14, 31, v12
    v_lshrrev_b32 v15, 5, v12
    v_lshrrev_b32 v56, 1, v14
    v_and_b32 v56, 7, v56
    v_lshlrev_b32 v57, 7, v14
    v_add_u32 v58, 0, v15
    v_xor_b32 v58, v58, v56
    v_lshl_add_u32 v2, v58, 4, v57
    v_add_u32 v58, 2, v15
    v_xor_b32 v58, v58, v56
    v_lshl_add_u32 v3, v58, 4, v57
    v_add_u32 v58, 4, v15
    v_xor_b32 v58, v58, v56
    v_lshl_add_u32 v4, v58, 4, v57
    v_add_u32 v58, 6, v15
    v_xor_b32 v58, v58, v56
    v_lshl_add_u32 v5, v58, 4, v57
    v_lshrrev_b32 v58, 1, v13
    v_lshlrev_b32 v58, 12, v58
    v_add_u32 v58, 8192, v58
    v_add_u32 v6, v2, v58
    v_add_u32 v7, v3, v58
    v_add_u32 v8, v4, v58
    v_add_u32 v9, v5, v58
    v_and_b32 v58, 1, v13
    v_lshlrev_b32 v58, 12, v58
    v_add_u32 v2, v2, v58
    v_add_u32 v3, v3, v58
    v_add_u32 v4, v4, v58
    v_add_u32 v5, v5, v58
    v_mov_b32 v64, 0
    v_mov_b32 v65, 0
    v_mov_b32 v66, 0
    v_mov_b32 v67, 0
    v_mov_b32 v68, 0
    v_mov_b32 v69, 0
    v_mov_b32 v70, 0
    v_mov_b32 v71, 0
    v_mov_b32 v72, 0
    v_mov_b32 v73, 0
    v_mov_b32 v74, 0
    v_mov_b32 v75, 0
    v_mov_b32 v76, 0
    v_mov_b32 v77, 0
    v_mov_b32 v78, 0
    v_mov_b32 v79, 0
    s_lshl_b32 s61, s28, 10
    s_add_u32 s62, s61, 0
    s_mov_b32 m0, s62
    buffer_load_dwordx4 v10, s[8:11], s64 offen lds
    s_add_u32 s62, s61, 4096
    s_mov_b32 m0, s62
    buffer_load_dwordx4 v10, s[8:11], s65 offen lds
    s_add_u32 s62, s61, 8192
    s_mov_b32 m0, s62
    buffer_load_dwordx4 v11, s[12:15], s68 offen lds
    s_add_u32 s62, s61, 12288
    s_mov_b32 m0, s62
    buffer_load_dwordx4 v11, s[12:15], s69 offen lds
    v_add_u32 v10, 0x80, v10
    v_add_u32 v11, 0x80, v11
    s_add_u32 s62, s61, 16384
    s_mov_b32 m0, s62
    buffer_load_dwordx4 v10, s[8:11], s64 offen lds
    s_add_u32 s62, s61, 20480
    s_mov_b32 m0, s62
    buffer_load_dwordx4 v10, s[8:11], s65 offen lds
    s_add_u32 s62, s61, 24576
    s_mov_b32 m0, s62
    buffer_load_dwordx4 v11, s[12:15], s68 offen lds
    s_add_u32 s62, s61, 28672
    s_mov_b32 m0, s62
    buffer_load_dwordx4 v11, s[12:15], s69 offen lds
    v_add_u32 v10, 0x80, v10
    v_add_u32 v11, 0x80, v11
    s_waitcnt vmcnt(4)
    s_barrier
    v_add_u32 v48, 0, v2
    v_add_u32 v49, 0, v6
    ds_read_b128 v[16:19], v48 offset:0
    ds_read_b128 v[20:23], v49
    v_add_u32 v48, 0, v3
    v_add_u32 v49, 0, v7
    ds_read_b128 v[24:27], v48 offset:0
    ds_read_b128 v[28:31], v49
    s_waitcnt lgkmcnt(2)
    v_mfma_f32_32x32x16_bf16 v[64:79], v[16:19], v[20:23], v[64:79]
    v_add_u32 v48, 0, v4
    v_add_u32 v49, 0, v8
    ds_read_b128 v[16:19], v48 offset:0
    ds_read_b128 v[20:23], v49
    s_waitcnt lgkmcnt(2)
    v_mfma_f32_32x32x16_bf16 v[64:79], v[24:27], v[28:31], v[64:79]
    s_waitcnt vmcnt(0)
    s_barrier
    s_add_u32 s62, s61, 32768
    s_mov_b32 m0, s62
    buffer_load_dwordx4 v10, s[8:11], s64 offen lds
    s_add_u32 s62, s61, 36864
    s_mov_b32 m0, s62
    buffer_load_dwordx4 v10, s[8:11], s65 offen lds
    s_add_u32 s62, s61, 40960
    s_mov_b32 m0, s62
    buffer_load_dwordx4 v11, s[12:15], s68 offen lds
    s_add_u32 s62, s61, 45056
    s_mov_b32 m0, s62
    buffer_load_dwordx4 v11, s[12:15], s69 offen lds
    v_add_u32 v10, 0x80, v10
    v_add_u32 v11, 0x80, v11
    v_add_u32 v48, 0, v5
    v_add_u32 v49, 0, v9
    ds_read_b128 v[24:27], v48 offset:0
    ds_read_b128 v[28:31], v49
    s_waitcnt lgkmcnt(2)
    v_mfma_f32_32x32x16_bf16 v[64:79], v[16:19], v[20:23], v[64:79]
    v_add_u32 v48, 16384, v2
    v_add_u32 v49, 16384, v6
    ds_read_b128 v[16:19], v48 offset:0
    ds_read_b128 v[20:23], v49
    s_waitcnt lgkmcnt(2)
    v_mfma_f32_32x32x16_bf16 v[64:79], v[24:27], v[28:31], v[64:79]
    v_add_u32 v48, 16384, v3
    v_add_u32 v49, 16384, v7
    ds_read_b128 v[24:27], v48 offset:0
    ds_read_b128 v[28:31], v49
    s_waitcnt lgkmcnt(2)
    v_mfma_f32_32x32x16_bf16 v[64:79], v[16:19], v[20:23], v[64:79]
    v_add_u32 v48, 16384, v4
    v_add_u32 v49, 16384, v8
    ds_read_b128 v[16:19], v48 offset:0
    ds_read_b128 v[20:23], v49
    s_waitcnt lgkmcnt(2)
    v_mfma_f32_32x32x16_bf16 v[64:79], v[24:27], v[28:31], v[64:79]
    s_waitcnt vmcnt(0)
    s_barrier
    s_add_u32 s62, s61, 0
    s_mov_b32 m0, s62
    buffer_load_dwordx4 v10, s[8:11], s64 offen lds
    s_add_u32 s62, s61, 4096
    s_mov_b32 m0, s62
    buffer_load_dwordx4 v10, s[8:11], s65 offen lds
    s_add_u32 s62, s61, 8192
    s_mov_b32 m0, s62
    buffer_load_dwordx4 v11, s[12:15], s68 offen lds
    s_add_u32 s62, s61, 12288
    s_mov_b32 m0, s62
    buffer_load_dwordx4 v11, s[12:15], s69 offen lds
    v_add_u32 v10, 0x80, v10
    v_add_u32 v11, 0x80, v11
    v_add_u32 v48, 16384, v5
    v_add_u32 v49, 16384, v9
    ds_read_b128 v[24:27], v48 offset:0
    ds_read_b128 v[28:31], v49
    s_waitcnt lgkmcnt(2)
    v_mfma_f32_32x32x16_bf16 v[64:79], v[16:19], v[20:23], v[64:79]
    v_add_u32 v48, 32768, v2
    v_add_u32 v49, 32768, v6
    ds_read_b128 v[16:19], v48 offset:0
    ds_read_b128 v[20:23], v49
    s_waitcnt lgkmcnt(2)
    v_mfma_f32_32x32x16_bf16 v[64:79], v[24:27], v[28:31], v[64:79]
    v_add_u32 v48, 32768, v3
    v_add_u32 v49, 32768, v7
    ds_read_b128 v[24:27], v48 offset:0
    ds_read_b128 v[28:31], v49
    s_waitcnt lgkmcnt(2)
    v_mfma_f32_32x32x16_bf16 v[64:79], v[16:19], v[20:23], v[64:79]
    v_add_u32 v48, 32768, v4
    v_add_u32 v49, 32768, v8
    ds_read_b128 v[16:19], v48 offset:0
    ds_read_b128 v[20:23], v49
    s_waitcnt lgkmcnt(2)
    v_mfma_f32_32x32x16_bf16 v[64:79], v[24:27], v[28:31], v[64:79]
    s_waitcnt vmcnt(0)
    s_barrier
    s_add_u32 s62, s61, 16384
    s_mov_b32 m0, s62
    buffer_load_dwordx4 v10, s[8:11], s64 offen lds
    s_add_u32 s62, s61, 20480
    s_mov_b32 m0, s62
    buffer_load_dwordx4 v10, s[8:11], s65 offen lds
    s_add_u32 s62, s61, 24576
    s_mov_b32 m0, s62
    buffer_load_dwordx4 v11, s[12:15], s68 offen lds
    s_add_u32 s62, s61, 28672
    s_mov_b32 m0, s62
    buffer_load_dwordx4 v11, s[12:15], s69 offen lds
    v_add_u32 v10, 0x80, v10
    v_add_u32 v11, 0x80, v11
    v_add_u32 v48, 32768, v5
    v_add_u32 v49, 32768, v9
    ds_read_b128 v[24:27], v48 offset:0
    ds_read_b128 v[28:31], v49
    s_waitcnt lgkmcnt(2)
    v_mfma_f32_32x32x16_bf16 v[64:79], v[16:19], v[20:23], v[64:79]
    v_add_u32 v48, 0, v2
    v_add_u32 v49, 0, v6
    ds_read_b128 v[16:19], v48 offset:0
    ds_read_b128 v[20:23], v49
    s_waitcnt lgkmcnt(2)
    v_mfma_f32_32x32x16_bf16 v[64:79], v[24:27], v[28:31], v[64:79]
    v_add_u32 v48, 0, v3
    v_add_u32 v49, 0, v7
    ds_read_b128 v[24:27], v48 offset:0
    ds_read_b128 v[28:31], v49
    s_waitcnt lgkmcnt(2)
    v_mfma_f32_32x32x16_bf16 v[64:79], v[16:19], v[20:23], v[64:79]
    v_add_u32 v48, 0, v4
    v_add_u32 v49, 0, v8
    ds_read_b128 v[16:19], v48 offset:0
    ds_read_b128 v[20:23], v49
    s_waitcnt lgkmcnt(2)
    v_mfma_f32_32x32x16_bf16 v[64:79], v[24:27], v[28:31], v[64:79]
    s_waitcnt vmcnt(0)
    s_barrier
    s_add_u32 s62, s61, 32768
    s_mov_b32 m0, s62
    buffer_load_dwordx4 v10, s[8:11], s64 offen lds
    s_add_u32 s62, s61, 36864
    s_mov_b32 m0, s62
    buffer_load_dwordx4 v10, s[8:11], s65 offen lds
    s_add_u32 s62, s61, 40960
    s_mov_b32 m0, s62
    buffer_load_dwordx4 v11, s[12:15], s68 offen lds
    s_add_u32 s62, s61, 45056
    s_mov_b32 m0, s62
    buffer_load_dwordx4 v11, s[12:15], s69 offen lds
    v_add_u32 v10, 0x80, v10
    v_add_u32 v11, 0x80, v11
    v_add_u32 v48, 0, v5
    v_add_u32 v49, 0, v9
    ds_read_b128 v[24:27], v48 offset:0
    ds_read_b128 v[28:31], v49
    s_waitcnt lgkmcnt(2)
    v_mfma_f32_32x32x16_bf16 v[64:79], v[16:19], v[20:23], v[64:79]
    v_add_u32 v48, 16384, v2
    v_add_u32 v49, 16384, v6
    ds_read_b128 v[16:19], v48 offset:0
    ds_read_b128 v[20:23], v49
    s_waitcnt lgkmcnt(2)
    v_mfma_f32_32x32x16_bf16 v[64:79], v[24:27], v[28:31], v[64:79]
    v_add_u32 v48, 16384, v3
    v_add_u32 v49, 16384, v7
    ds_read_b128 v[24:27], v48 offset:0
    ds_read_b128 v[28:31], v49
    s_waitcnt lgkmcnt(2)
    v_mfma_f32_32x32x16_bf16 v[64:79], v[16:19], v[20:23], v[64:79]
    v_add_u32 v48, 16384, v4
    v_add_u32 v49, 16384, v8
    ds_read_b128 v[16:19], v48 offset:0
    ds_read_b128 v[20:23], v49
    s_waitcnt lgkmcnt(2)
    v_mfma_f32_32x32x16_bf16 v[64:79], v[24:27], v[28:31], v[64:79]
    s_waitcnt vmcnt(0)
    s_barrier
    s_add_u32 s62, s61, 0
    s_mov_b32 m0, s62
    buffer_load_dwordx4 v10, s[8:11], s64 offen lds
    s_add_u32 s62, s61, 4096
    s_mov_b32 m0, s62
    buffer_load_dwordx4 v10, s[8:11], s65 offen lds
    s_add_u32 s62, s61, 8192
    s_mov_b32 m0, s62
    buffer_load_dwordx4 v11, s[12:15], s68 offen lds
    s_add_u32 s62, s61, 12288
    s_mov_b32 m0, s62
    buffer_load_dwordx4 v11, s[12:15], s69 offen lds
    v_add_u32 v10, 0x80, v10
    v_add_u32 v11, 0x80, v11
    v_add_u32 v48, 16384, v5
    v_add_u32 v49, 16384, v9
    ds_read_b128 v[24:27], v48 offset:0
    ds_read_b128 v[28:31], v49
    s_waitcnt lgkmcnt(2)
    v_mfma_f32_32x32x16_bf16 v[64:79], v[16:19], v[20:23], v[64:79]
    v_add_u32 v48, 32768, v2
    v_add_u32 v49, 32768, v6
    ds_read_b128 v[16:19], v48 offset:0
    ds_read_b128 v[20:23], v49
    s_waitcnt lgkmcnt(2)
    v_mfma_f32_32x32x16_bf16 v[64:79], v[24:27], v[28:31], v[64:79]
    v_add_u32 v48, 32768, v3
    v_add_u32 v49, 32768, v7
    ds_read_b128 v[24:27], v48 offset:0
    ds_read_b128 v[28:31], v49
    s_waitcnt lgkmcnt(2)
    v_mfma_f32_32x32x16_bf16 v[64:79], v[16:19], v[20:23], v[64:79]
    v_add_u32 v48, 32768, v4
    v_add_u32 v49, 32768, v8
    ds_read_b128 v[16:19], v48 offset:0
    ds_read_b128 v[20:23], v49
    s_waitcnt lgkmcnt(2)
    v_mfma_f32_32x32x16_bf16 v[64:79], v[24:27], v[28:31], v[64:79]
    s_waitcnt vmcnt(0)
    s_barrier
    s_add_u32 s62, s61, 16384
    s_mov_b32 m0, s62
    buffer_load_dwordx4 v10, s[8:11], s64 offen lds
    s_add_u32 s62, s61, 20480
    s_mov_b32 m0, s62
    buffer_load_dwordx4 v10, s[8:11], s65 offen lds
    s_add_u32 s62, s61, 24576
    s_mov_b32 m0, s62
    buffer_load_dwordx4 v11, s[12:15], s68 offen lds
    s_add_u32 s62, s61, 28672
    s_mov_b32 m0, s62
    buffer_load_dwordx4 v11, s[12:15], s69 offen lds
    v_add_u32 v10, 0x80, v10
    v_add_u32 v11, 0x80, v11
    v_add_u32 v48, 32768, v5
    v_add_u32 v49, 32768, v9
    ds_read_b128 v[24:27], v48 offset:0
    ds_read_b128 v[28:31], v49
    s_waitcnt lgkmcnt(2)
    v_mfma_f32_32x32x16_bf16 v[64:79], v[16:19], v[20:23], v[64:79]
    v_add_u32 v48, 0, v2
    v_add_u32 v49, 0, v6
    ds_read_b128 v[16:19], v48 offset:0
    ds_read_b128 v[20:23], v49
    s_waitcnt lgkmcnt(2)
    v_mfma_f32_32x32x16_bf16 v[64:79], v[24:27], v[28:31], v[64:79]
    v_add_u32 v48, 0, v3
    v_add_u32 v49, 0, v7
    ds_read_b128 v[24:27], v48 offset:0
    ds_read_b128 v[28:31], v49
    s_waitcnt lgkmcnt(2)
    v_mfma_f32_32x32x16_bf16 v[64:79], v[16:19], v[20:23], v[64:79]
    v_add_u32 v48, 0, v4
    v_add_u32 v49, 0, v8
    ds_read_b128 v[16:19], v48 offset:0
    ds_read_b128 v[20:23], v49
    s_waitcnt lgkmcnt(2)
    v_mfma_f32_32x32x16_bf16 v[64:79], v[24:27], v[28:31], v[64:79]
    s_waitcnt vmcnt(0)
    s_barrier
    s_add_u32 s62, s61, 32768
    s_mov_b32 m0, s62
    buffer_load_dwordx4 v10, s[8:11], s64 offen lds
    s_add_u32 s62, s61, 36864
    s_mov_b32 m0, s62
    buffer_load_dwordx4 v10, s[8:11], s65 offen lds
    s_add_u32 s62, s61, 40960
    s_mov_b32 m0, s62
    buffer_load_dwordx4 v11, s[12:15], s68 offen lds
    s_add_u32 s62, s61, 45056
    s_mov_b32 m0, s62
    buffer_load_dwordx4 v11, s[12:15], s69 offen lds
    v_add_u32 v10, 0x80, v10
    v_add_u32 v11, 0x80, v11
    v_add_u32 v48, 0, v5
    v_add_u32 v49, 0, v9
    ds_read_b128 v[24:27], v48 offset:0
    ds_read_b128 v[28:31], v49
    s_waitcnt lgkmcnt(2)
    v_mfma_f32_32x32x16_bf16 v[64:79], v[16:19], v[20:23], v[64:79]
    v_add_u32 v48, 16384, v2
    v_add_u32 v49, 16384, v6
    ds_read_b128 v[16:19], v48 offset:0
    ds_read_b128 v[20:23], v49
    s_waitcnt lgkmcnt(2)
    v_mfma_f32_32x32x16_bf16 v[64:79], v[24:27], v[28:31], v[64:79]
    v_add_u32 v48, 16384, v3
    v_add_u32 v49, 16384, v7
    ds_read_b128 v[24:27], v48 offset:0
    ds_read_b128 v[28:31], v49
    s_waitcnt lgkmcnt(2)
    v_mfma_f32_32x32x16_bf16 v[64:79], v[16:19], v[20:23], v[64:79]
    v_add_u32 v48, 16384, v4
    v_add_u32 v49, 16384, v8
    ds_read_b128 v[16:19], v48 offset:0
    ds_read_b128 v[20:23], v49
    s_waitcnt lgkmcnt(2)
    v_mfma_f32_32x32x16_bf16 v[64:79], v[24:27], v[28:31], v[64:79]
    s_waitcnt vmcnt(0)
    s_barrier
    s_add_u32 s62, s61, 0
    s_mov_b32 m0, s62
    buffer_load_dwordx4 v10, s[8:11], s64 offen lds
    s_add_u32 s62, s61, 4096
    s_mov_b32 m0, s62
    buffer_load_dwordx4 v10, s[8:11], s65 offen lds
    s_add_u32 s62, s61, 8192
    s_mov_b32 m0, s62
    buffer_load_dwordx4 v11, s[12:15], s68 offen lds
    s_add_u32 s62, s61, 12288
    s_mov_b32 m0, s62
    buffer_load_dwordx4 v11, s[12:15], s69 offen lds
    v_add_u32 v10, 0x80, v10
    v_add_u32 v11, 0x80, v11
    v_add_u32 v48, 16384, v5
    v_add_u32 v49, 16384, v9
    ds_read_b128 v[24:27], v48 offset:0
    ds_read_b128 v[28:31], v49
    s_waitcnt lgkmcnt(2)
    v_mfma_f32_32x32x16_bf16 v[64:79], v[16:19], v[20:23], v[64:79]
    v_add_u32 v48, 32768, v2
    v_add_u32 v49, 32768, v6
    ds_read_b128 v[16:19], v48 offset:0
    ds_read_b128 v[20:23], v49
    s_waitcnt lgkmcnt(2)
    v_mfma_f32_32x32x16_bf16 v[64:79], v[24:27], v[28:31], v[64:79]
    v_add_u32 v48, 32768, v3
    v_add_u32 v49, 32768, v7
    ds_read_b128 v[24:27], v48 offset:0
    ds_read_b128 v[28:31], v49
    s_waitcnt lgkmcnt(2)
    v_mfma_f32_32x32x16_bf16 v[64:79], v[16:19], v[20:23], v[64:79]
    v_add_u32 v48, 32768, v4
    v_add_u32 v49, 32768, v8
    ds_read_b128 v[16:19], v48 offset:0
    ds_read_b128 v[20:23], v49
    s_waitcnt lgkmcnt(2)
    v_mfma_f32_32x32x16_bf16 v[64:79], v[24:27], v[28:31], v[64:79]
    s_waitcnt vmcnt(0)
    s_barrier
    s_add_u32 s62, s61, 16384
    s_mov_b32 m0, s62
    buffer_load_dwordx4 v10, s[8:11], s64 offen lds
    s_add_u32 s62, s61, 20480
    s_mov_b32 m0, s62
    buffer_load_dwordx4 v10, s[8:11], s65 offen lds
    s_add_u32 s62, s61, 24576
    s_mov_b32 m0, s62
    buffer_load_dwordx4 v11, s[12:15], s68 offen lds
    s_add_u32 s62, s61, 28672
    s_mov_b32 m0, s62
    buffer_load_dwordx4 v11, s[12:15], s69 offen lds
    v_add_u32 v10, 0x80, v10
    v_add_u32 v11, 0x80, v11
    v_add_u32 v48, 32768, v5
    v_add_u32 v49, 32768, v9
    ds_read_b128 v[24:27], v48 offset:0
    ds_read_b128 v[28:31], v49
    s_waitcnt lgkmcnt(2)
    v_mfma_f32_32x32x16_bf16 v[64:79], v[16:19], v[20:23], v[64:79]
    v_add_u32 v48, 0, v2
    v_add_u32 v49, 0, v6
    ds_read_b128 v[16:19], v48 offset:0
    ds_read_b128 v[20:23], v49
    s_waitcnt lgkmcnt(2)
    v_mfma_f32_32x32x16_bf16 v[64:79], v[24:27], v[28:31], v[64:79]
    v_add_u32 v48, 0, v3
    v_add_u32 v49, 0, v7
    ds_read_b128 v[24:27], v48 offset:0
    ds_read_b128 v[28:31], v49
    s_waitcnt lgkmcnt(2)
    v_mfma_f32_32x32x16_bf16 v[64:79], v[16:19], v[20:23], v[64:79]
    v_add_u32 v48, 0, v4
    v_add_u32 v49, 0, v8
    ds_read_b128 v[16:19], v48 offset:0
    ds_read_b128 v[20:23], v49
    s_waitcnt lgkmcnt(2)
    v_mfma_f32_32x32x16_bf16 v[64:79], v[24:27], v[28:31], v[64:79]
    s_waitcnt vmcnt(0)
    s_barrier
    s_add_u32 s62, s61, 32768
    s_mov_b32 m0, s62
    buffer_load_dwordx4 v10, s[8:11], s64 offen lds
    s_add_u32 s62, s61, 36864
    s_mov_b32 m0, s62
    buffer_load_dwordx4 v10, s[8:11], s65 offen lds
    s_add_u32 s62, s61, 40960
    s_mov_b32 m0, s62
    buffer_load_dwordx4 v11, s[12:15], s68 offen lds
    s_add_u32 s62, s61, 45056
    s_mov_b32 m0, s62
    buffer_load_dwordx4 v11, s[12:15], s69 offen lds
    v_add_u32 v10, 0x80, v10
    v_add_u32 v11, 0x80, v11
    v_add_u32 v48, 0, v5
    v_add_u32 v49, 0, v9
    ds_read_b128 v[24:27], v48 offset:0
    ds_read_b128 v[28:31], v49
    s_waitcnt lgkmcnt(2)
    v_mfma_f32_32x32x16_bf16 v[64:79], v[16:19], v[20:23], v[64:79]
    v_add_u32 v48, 16384, v2
    v_add_u32 v49, 16384, v6
    ds_read_b128 v[16:19], v48 offset:0
    ds_read_b128 v[20:23], v49
    s_waitcnt lgkmcnt(2)
    v_mfma_f32_32x32x16_bf16 v[64:79], v[24:27], v[28:31], v[64:79]
    v_add_u32 v48, 16384, v3
    v_add_u32 v49, 16384, v7
    ds_read_b128 v[24:27], v48 offset:0
    ds_read_b128 v[28:31], v49
    s_waitcnt lgkmcnt(2)
    v_mfma_f32_32x32x16_bf16 v[64:79], v[16:19], v[20:23], v[64:79]
    v_add_u32 v48, 16384, v4
    v_add_u32 v49, 16384, v8
    ds_read_b128 v[16:19], v48 offset:0
    ds_read_b128 v[20:23], v49
    s_waitcnt lgkmcnt(2)
    v_mfma_f32_32x32x16_bf16 v[64:79], v[24:27], v[28:31], v[64:79]
    s_waitcnt vmcnt(0)
    s_barrier
    s_add_u32 s62, s61, 0
    s_mov_b32 m0, s62
    buffer_load_dwordx4 v10, s[8:11], s64 offen lds
    s_add_u32 s62, s61, 4096
    s_mov_b32 m0, s62
    buffer_load_dwordx4 v10, s[8:11], s65 offen lds
    s_add_u32 s62, s61, 8192
    s_mov_b32 m0, s62
    buffer_load_dwordx4 v11, s[12:15], s68 offen lds
    s_add_u32 s62, s61, 12288
    s_mov_b32 m0, s62
    buffer_load_dwordx4 v11, s[12:15], s69 offen lds
    v_add_u32 v10, 0x80, v10
    v_add_u32 v11, 0x80, v11
    v_add_u32 v48, 16384, v5
    v_add_u32 v49, 16384, v9
    ds_read_b128 v[24:27], v48 offset:0
    ds_read_b128 v[28:31], v49
    s_waitcnt lgkmcnt(2)
    v_mfma_f32_32x32x16_bf16 v[64:79], v[16:19], v[20:23], v[64:79]
    v_add_u32 v48, 32768, v2
    v_add_u32 v49, 32768, v6
    ds_read_b128 v[16:19], v48 offset:0
    ds_read_b128 v[20:23], v49
    s_waitcnt lgkmcnt(2)
    v_mfma_f32_32x32x16_bf16 v[64:79], v[24:27], v[28:31], v[64:79]
    v_add_u32 v48, 32768, v3
    v_add_u32 v49, 32768, v7
    ds_read_b128 v[24:27], v48 offset:0
    ds_read_b128 v[28:31], v49
    s_waitcnt lgkmcnt(2)
    v_mfma_f32_32x32x16_bf16 v[64:79], v[16:19], v[20:23], v[64:79]
    v_add_u32 v48, 32768, v4
    v_add_u32 v49, 32768, v8
    ds_read_b128 v[16:19], v48 offset:0
    ds_read_b128 v[20:23], v49
    s_waitcnt lgkmcnt(2)
    v_mfma_f32_32x32x16_bf16 v[64:79], v[24:27], v[28:31], v[64:79]
    s_waitcnt vmcnt(0)
    s_barrier
    s_add_u32 s62, s61, 16384
    s_mov_b32 m0, s62
    buffer_load_dwordx4 v10, s[8:11], s64 offen lds
    s_add_u32 s62, s61, 20480
    s_mov_b32 m0, s62
    buffer_load_dwordx4 v10, s[8:11], s65 offen lds
    s_add_u32 s62, s61, 24576
    s_mov_b32 m0, s62
    buffer_load_dwordx4 v11, s[12:15], s68 offen lds
    s_add_u32 s62, s61, 28672
    s_mov_b32 m0, s62
    buffer_load_dwordx4 v11, s[12:15], s69 offen lds
    v_add_u32 v10, 0x80, v10
    v_add_u32 v11, 0x80, v11
    v_add_u32 v48, 32768, v5
    v_add_u32 v49, 32768, v9
    ds_read_b128 v[24:27], v48 offset:0
    ds_read_b128 v[28:31], v49
    s_waitcnt lgkmcnt(2)
    v_mfma_f32_32x32x16_bf16 v[64:79], v[16:19], v[20:23], v[64:79]
    v_add_u32 v48, 0, v2
    v_add_u32 v49, 0, v6
    ds_read_b128 v[16:19], v48 offset:0
    ds_read_b128 v[20:23], v49
    s_waitcnt lgkmcnt(2)
    v_mfma_f32_32x32x16_bf16 v[64:79], v[24:27], v[28:31], v[64:79]
    v_add_u32 v48, 0, v3
    v_add_u32 v49, 0, v7
    ds_read_b128 v[24:27], v48 offset:0
    ds_read_b128 v[28:31], v49
    s_waitcnt lgkmcnt(2)
    v_mfma_f32_32x32x16_bf16 v[64:79], v[16:19], v[20:23], v[64:79]
    v_add_u32 v48, 0, v4
    v_add_u32 v49, 0, v8
    ds_read_b128 v[16:19], v48 offset:0
    ds_read_b128 v[20:23], v49
    s_waitcnt lgkmcnt(2)
    v_mfma_f32_32x32x16_bf16 v[64:79], v[24:27], v[28:31], v[64:79]
    s_waitcnt vmcnt(0)
    s_barrier
    s_add_u32 s62, s61, 32768
    s_mov_b32 m0, s62
    buffer_load_dwordx4 v10, s[8:11], s64 offen lds
    s_add_u32 s62, s61, 36864
    s_mov_b32 m0, s62
    buffer_load_dwordx4 v10, s[8:11], s65 offen lds
    s_add_u32 s62, s61, 40960
    s_mov_b32 m0, s62
    buffer_load_dwordx4 v11, s[12:15], s68 offen lds
    s_add_u32 s62, s61, 45056
    s_mov_b32 m0, s62
    buffer_load_dwordx4 v11, s[12:15], s69 offen lds
    v_add_u32 v10, 0x80, v10
    v_add_u32 v11, 0x80, v11
    v_add_u32 v48, 0, v5
    v_add_u32 v49, 0, v9
    ds_read_b128 v[24:27], v48 offset:0
    ds_read_b128 v[28:31], v49
    s_waitcnt lgkmcnt(2)
    v_mfma_f32_32x32x16_bf16 v[64:79], v[16:19], v[20:23], v[64:79]
    v_add_u32 v48, 16384, v2
    v_add_u32 v49, 16384, v6
    ds_read_b128 v[16:19], v48 offset:0
    ds_read_b128 v[20:23], v49
    s_waitcnt lgkmcnt(2)
    v_mfma_f32_32x32x16_bf16 v[64:79], v[24:27], v[28:31], v[64:79]
    v_add_u32 v48, 16384, v3
    v_add_u32 v49, 16384, v7
    ds_read_b128 v[24:27], v48 offset:0
    ds_read_b128 v[28:31], v49
    s_waitcnt lgkmcnt(2)
    v_mfma_f32_32x32x16_bf16 v[64:79], v[16:19], v[20:23], v[64:79]
    v_add_u32 v48, 16384, v4
    v_add_u32 v49, 16384, v8
    ds_read_b128 v[16:19], v48 offset:0
    ds_read_b128 v[20:23], v49
    s_waitcnt lgkmcnt(2)
    v_mfma_f32_32x32x16_bf16 v[64:79], v[24:27], v[28:31], v[64:79]
    s_waitcnt vmcnt(0)
    s_barrier
    s_add_u32 s62, s61, 0
    s_mov_b32 m0, s62
    buffer_load_dwordx4 v10, s[8:11], s64 offen lds
    s_add_u32 s62, s61, 4096
    s_mov_b32 m0, s62
    buffer_load_dwordx4 v10, s[8:11], s65 offen lds
    s_add_u32 s62, s61, 8192
    s_mov_b32 m0, s62
    buffer_load_dwordx4 v11, s[12:15], s68 offen lds
    s_add_u32 s62, s61, 12288
    s_mov_b32 m0, s62
    buffer_load_dwordx4 v11, s[12:15], s69 offen lds
    v_add_u32 v10, 0x80, v10
    v_add_u32 v11, 0x80, v11
    v_add_u32 v48, 16384, v5
    v_add_u32 v49, 16384, v9
    ds_read_b128 v[24:27], v48 offset:0
    ds_read_b128 v[28:31], v49
    s_waitcnt lgkmcnt(2)
    v_mfma_f32_32x32x16_bf16 v[64:79], v[16:19], v[20:23], v[64:79]
    v_add_u32 v48, 32768, v2
    v_add_u32 v49, 32768, v6
    ds_read_b128 v[16:19], v48 offset:0
    ds_read_b128 v[20:23], v49
    s_waitcnt lgkmcnt(2)
    v_mfma_f32_32x32x16_bf16 v[64:79], v[24:27], v[28:31], v[64:79]
    v_add_u32 v48, 32768, v3
    v_add_u32 v49, 32768, v7
    ds_read_b128 v[24:27], v48 offset:0
    ds_read_b128 v[28:31], v49
    s_waitcnt lgkmcnt(2)
    v_mfma_f32_32x32x16_bf16 v[64:79], v[16:19], v[20:23], v[64:79]
    v_add_u32 v48, 32768, v4
    v_add_u32 v49, 32768, v8
    ds_read_b128 v[16:19], v48 offset:0
    ds_read_b128 v[20:23], v49
    s_waitcnt lgkmcnt(2)
    v_mfma_f32_32x32x16_bf16 v[64:79], v[24:27], v[28:31], v[64:79]
    s_waitcnt vmcnt(0)
    s_barrier
    s_add_u32 s62, s61, 16384
    s_mov_b32 m0, s62
    buffer_load_dwordx4 v10, s[8:11], s64 offen lds
    s_add_u32 s62, s61, 20480
    s_mov_b32 m0, s62
    buffer_load_dwordx4 v10, s[8:11], s65 offen lds
    s_add_u32 s62, s61, 24576
    s_mov_b32 m0, s62
    buffer_load_dwordx4 v11, s[12:15], s68 offen lds
    s_add_u32 s62, s61, 28672
    s_mov_b32 m0, s62
    buffer_load_dwordx4 v11, s[12:15], s69 offen lds
    v_add_u32 v10, 0x80, v10
    v_add_u32 v11, 0x80, v11
    v_add_u32 v48, 32768, v5
    v_add_u32 v49, 32768, v9
    ds_read_b128 v[24:27], v48 offset:0
    ds_read_b128 v[28:31], v49
    s_waitcnt lgkmcnt(2)
    v_mfma_f32_32x32x16_bf16 v[64:79], v[16:19], v[20:23], v[64:79]
    v_add_u32 v48, 0, v2
    v_add_u32 v49, 0, v6
    ds_read_b128 v[16:19], v48 offset:0
    ds_read_b128 v[20:23], v49
    s_waitcnt lgkmcnt(2)
    v_mfma_f32_32x32x16_bf16 v[64:79], v[24:27], v[28:31], v[64:79]
    v_add_u32 v48, 0, v3
    v_add_u32 v49, 0, v7
    ds_read_b128 v[24:27], v48 offset:0
    ds_read_b128 v[28:31], v49
    s_waitcnt lgkmcnt(2)
    v_mfma_f32_32x32x16_bf16 v[64:79], v[16:19], v[20:23], v[64:79]
    v_add_u32 v48, 0, v4
    v_add_u32 v49, 0, v8
    ds_read_b128 v[16:19], v48 offset:0
    ds_read_b128 v[20:23], v49
    s_waitcnt lgkmcnt(2)
    v_mfma_f32_32x32x16_bf16 v[64:79], v[24:27], v[28:31], v[64:79]
    s_waitcnt vmcnt(0)
    s_barrier
    s_add_u32 s62, s61, 32768
    s_mov_b32 m0, s62
    buffer_load_dwordx4 v10, s[8:11], s64 offen lds
    s_add_u32 s62, s61, 36864
    s_mov_b32 m0, s62
    buffer_load_dwordx4 v10, s[8:11], s65 offen lds
    s_add_u32 s62, s61, 40960
    s_mov_b32 m0, s62
    buffer_load_dwordx4 v11, s[12:15], s68 offen lds
    s_add_u32 s62, s61, 45056
    s_mov_b32 m0, s62
    buffer_load_dwordx4 v11, s[12:15], s69 offen lds
    v_add_u32 v10, 0x80, v10
    v_add_u32 v11, 0x80, v11
    v_add_u32 v48, 0, v5
    v_add_u32 v49, 0, v9
    ds_read_b128 v[24:27], v48 offset:0
    ds_read_b128 v[28:31], v49
    s_waitcnt lgkmcnt(2)
    v_mfma_f32_32x32x16_bf16 v[64:79], v[16:19], v[20:23], v[64:79]
    v_add_u32 v48, 16384, v2
    v_add_u32 v49, 16384, v6
    ds_read_b128 v[16:19], v48 offset:0
    ds_read_b128 v[20:23], v49
    s_waitcnt lgkmcnt(2)
    v_mfma_f32_32x32x16_bf16 v[64:79], v[24:27], v[28:31], v[64:79]
    v_add_u32 v48, 16384, v3
    v_add_u32 v49, 16384, v7
    ds_read_b128 v[24:27], v48 offset:0
    ds_read_b128 v[28:31], v49
    s_waitcnt lgkmcnt(2)
    v_mfma_f32_32x32x16_bf16 v[64:79], v[16:19], v[20:23], v[64:79]
    v_add_u32 v48, 16384, v4
    v_add_u32 v49, 16384, v8
    ds_read_b128 v[16:19], v48 offset:0
    ds_read_b128 v[20:23], v49
    s_waitcnt lgkmcnt(2)
    v_mfma_f32_32x32x16_bf16 v[64:79], v[24:27], v[28:31], v[64:79]
    s_waitcnt vmcnt(0)
    s_barrier
    s_add_u32 s62, s61, 0
    s_mov_b32 m0, s62
    buffer_load_dwordx4 v10, s[8:11], s64 offen lds
    s_add_u32 s62, s61, 4096
    s_mov_b32 m0, s62
    buffer_load_dwordx4 v10, s[8:11], s65 offen lds
    s_add_u32 s62, s61, 8192
    s_mov_b32 m0, s62
    buffer_load_dwordx4 v11, s[12:15], s68 offen lds
    s_add_u32 s62, s61, 12288
    s_mov_b32 m0, s62
    buffer_load_dwordx4 v11, s[12:15], s69 offen lds
    v_add_u32 v10, 0x80, v10
    v_add_u32 v11, 0x80, v11
    v_add_u32 v48, 16384, v5
    v_add_u32 v49, 16384, v9
    ds_read_b128 v[24:27], v48 offset:0
    ds_read_b128 v[28:31], v49
    s_waitcnt lgkmcnt(2)
    v_mfma_f32_32x32x16_bf16 v[64:79], v[16:19], v[20:23], v[64:79]
    v_add_u32 v48, 32768, v2
    v_add_u32 v49, 32768, v6
    ds_read_b128 v[16:19], v48 offset:0
    ds_read_b128 v[20:23], v49
    s_waitcnt lgkmcnt(2)
    v_mfma_f32_32x32x16_bf16 v[64:79], v[24:27], v[28:31], v[64:79]
    v_add_u32 v48, 32768, v3
    v_add_u32 v49, 32768, v7
    ds_read_b128 v[24:27], v48 offset:0
    ds_read_b128 v[28:31], v49
    s_waitcnt lgkmcnt(2)
    v_mfma_f32_32x32x16_bf16 v[64:79], v[16:19], v[20:23], v[64:79]
    v_add_u32 v48, 32768, v4
    v_add_u32 v49, 32768, v8
    ds_read_b128 v[16:19], v48 offset:0
    ds_read_b128 v[20:23], v49
    s_waitcnt lgkmcnt(2)
    v_mfma_f32_32x32x16_bf16 v[64:79], v[24:27], v[28:31], v[64:79]
    s_waitcnt vmcnt(0)
    s_barrier
    s_add_u32 s62, s61, 16384
    s_mov_b32 m0, s62
    buffer_load_dwordx4 v10, s[8:11], s64 offen lds
    s_add_u32 s62, s61, 20480
    s_mov_b32 m0, s62
    buffer_load_dwordx4 v10, s[8:11], s65 offen lds
    s_add_u32 s62, s61, 24576
    s_mov_b32 m0, s62
    buffer_load_dwordx4 v11, s[12:15], s68 offen lds
    s_add_u32 s62, s61, 28672
    s_mov_b32 m0, s62
    buffer_load_dwordx4 v11, s[12:15], s69 offen lds
    v_add_u32 v10, 0x80, v10
    v_add_u32 v11, 0x80, v11
    v_add_u32 v48, 32768, v5
    v_add_u32 v49, 32768, v9
    ds_read_b128 v[24:27], v48 offset:0
    ds_read_b128 v[28:31], v49
    s_waitcnt lgkmcnt(2)
    v_mfma_f32_32x32x16_bf16 v[64:79], v[16:19], v[20:23], v[64:79]
    v_add_u32 v48, 0, v2
    v_add_u32 v49, 0, v6
    ds_read_b128 v[16:19], v48 offset:0
    ds_read_b128 v[20:23], v49
    s_waitcnt lgkmcnt(2)
    v_mfma_f32_32x32x16_bf16 v[64:79], v[24:27], v[28:31], v[64:79]
    v_add_u32 v48, 0, v3
    v_add_u32 v49, 0, v7
    ds_read_b128 v[24:27], v48 offset:0
    ds_read_b128 v[28:31], v49
    s_waitcnt lgkmcnt(2)
    v_mfma_f32_32x32x16_bf16 v[64:79], v[16:19], v[20:23], v[64:79]
    v_add_u32 v48, 0, v4
    v_add_u32 v49, 0, v8
    ds_read_b128 v[16:19], v48 offset:0
    ds_read_b128 v[20:23], v49
    s_waitcnt lgkmcnt(2)
    v_mfma_f32_32x32x16_bf16 v[64:79], v[24:27], v[28:31], v[64:79]
    s_waitcnt vmcnt(0)
    s_barrier
    s_add_u32 s62, s61, 32768
    s_mov_b32 m0, s62
    buffer_load_dwordx4 v10, s[8:11], s64 offen lds
    s_add_u32 s62, s61, 36864
    s_mov_b32 m0, s62
    buffer_load_dwordx4 v10, s[8:11], s65 offen lds
    s_add_u32 s62, s61, 40960
    s_mov_b32 m0, s62
    buffer_load_dwordx4 v11, s[12:15], s68 offen lds
    s_add_u32 s62, s61, 45056
    s_mov_b32 m0, s62
    buffer_load_dwordx4 v11, s[12:15], s69 offen lds
    v_add_u32 v10, 0x80, v10
    v_add_u32 v11, 0x80, v11
    v_add_u32 v48, 0, v5
    v_add_u32 v49, 0, v9
    ds_read_b128 v[24:27], v48 offset:0
    ds_read_b128 v[28:31], v49
    s_waitcnt lgkmcnt(2)
    v_mfma_f32_32x32x16_bf16 v[64:79], v[16:19], v[20:23], v[64:79]
    v_add_u32 v48, 16384, v2
    v_add_u32 v49, 16384, v6
    ds_read_b128 v[16:19], v48 offset:0
    ds_read_b128 v[20:23], v49
    s_waitcnt lgkmcnt(2)
    v_mfma_f32_32x32x16_bf16 v[64:79], v[24:27], v[28:31], v[64:79]
    v_add_u32 v48, 16384, v3
    v_add_u32 v49, 16384, v7
    ds_read_b128 v[24:27], v48 offset:0
    ds_read_b128 v[28:31], v49
    s_waitcnt lgkmcnt(2)
    v_mfma_f32_32x32x16_bf16 v[64:79], v[16:19], v[20:23], v[64:79]
    v_add_u32 v48, 16384, v4
    v_add_u32 v49, 16384, v8
    ds_read_b128 v[16:19], v48 offset:0
    ds_read_b128 v[20:23], v49
    s_waitcnt lgkmcnt(2)
    v_mfma_f32_32x32x16_bf16 v[64:79], v[24:27], v[28:31], v[64:79]
    s_waitcnt vmcnt(0)
    s_barrier
    s_add_u32 s62, s61, 0
    s_mov_b32 m0, s62
    buffer_load_dwordx4 v10, s[8:11], s64 offen lds
    s_add_u32 s62, s61, 4096
    s_mov_b32 m0, s62
    buffer_load_dwordx4 v10, s[8:11], s65 offen lds
    s_add_u32 s62, s61, 8192
    s_mov_b32 m0, s62
    buffer_load_dwordx4 v11, s[12:15], s68 offen lds
    s_add_u32 s62, s61, 12288
    s_mov_b32 m0, s62
    buffer_load_dwordx4 v11, s[12:15], s69 offen lds
    v_add_u32 v10, 0x80, v10
    v_add_u32 v11, 0x80, v11
    v_add_u32 v48, 16384, v5
    v_add_u32 v49, 16384, v9
    ds_read_b128 v[24:27], v48 offset:0
    ds_read_b128 v[28:31], v49
    s_waitcnt lgkmcnt(2)
    v_mfma_f32_32x32x16_bf16 v[64:79], v[16:19], v[20:23], v[64:79]
    v_add_u32 v48, 32768, v2
    v_add_u32 v49, 32768, v6
    ds_read_b128 v[16:19], v48 offset:0
    ds_read_b128 v[20:23], v49
    s_waitcnt lgkmcnt(2)
    v_mfma_f32_32x32x16_bf16 v[64:79], v[24:27], v[28:31], v[64:79]
    v_add_u32 v48, 32768, v3
    v_add_u32 v49, 32768, v7
    ds_read_b128 v[24:27], v48 offset:0
    ds_read_b128 v[28:31], v49
    s_waitcnt lgkmcnt(2)
    v_mfma_f32_32x32x16_bf16 v[64:79], v[16:19], v[20:23], v[64:79]
    v_add_u32 v48, 32768, v4
    v_add_u32 v49, 32768, v8
    ds_read_b128 v[16:19], v48 offset:0
    ds_read_b128 v[20:23], v49
    s_waitcnt lgkmcnt(2)
    v_mfma_f32_32x32x16_bf16 v[64:79], v[24:27], v[28:31], v[64:79]
    s_waitcnt vmcnt(0)
    s_barrier
    v_add_u32 v48, 32768, v5
    v_add_u32 v49, 32768, v9
    ds_read_b128 v[24:27], v48 offset:0
    ds_read_b128 v[28:31], v49
    s_waitcnt lgkmcnt(2)
    v_mfma_f32_32x32x16_bf16 v[64:79], v[16:19], v[20:23], v[64:79]
    v_add_u32 v48, 0, v2
    v_add_u32 v49, 0, v6
    ds_read_b128 v[16:19], v48 offset:0
    ds_read_b128 v[20:23], v49
    s_waitcnt lgkmcnt(2)
    v_mfma_f32_32x32x16_bf16 v[64:79], v[24:27], v[28:31], v[64:79]
    v_add_u32 v48, 0, v3
    v_add_u32 v49, 0, v7
    ds_read_b128 v[24:27], v48 offset:0
    ds_read_b128 v[28:31], v49
    s_waitcnt lgkmcnt(2)
    v_mfma_f32_32x32x16_bf16 v[64:79], v[16:19], v[20:23], v[64:79]
    v_add_u32 v48, 0, v4
    v_add_u32 v49, 0, v8
    ds_read_b128 v[16:19], v48 offset:0
    ds_read_b128 v[20:23], v49
    s_waitcnt lgkmcnt(2)
    v_mfma_f32_32x32x16_bf16 v[64:79], v[24:27], v[28:31], v[64:79]
    v_add_u32 v48, 0, v5
    v_add_u32 v49, 0, v9
    ds_read_b128 v[24:27], v48 offset:0
    ds_read_b128 v[28:31], v49
    s_waitcnt lgkmcnt(2)
    v_mfma_f32_32x32x16_bf16 v[64:79], v[16:19], v[20:23], v[64:79]
    s_waitcnt lgkmcnt(0)
    v_mfma_f32_32x32x16_bf16 v[64:79], v[24:27], v[28:31], v[64:79]
    v_and_b32 v14, 31, v12
    v_lshrrev_b32 v15, 5, v12
    v_lshrrev_b32 v16, 1, v13
    v_lshl_add_u32 v14, v16, 5, v14
    v_add_u32 v14, s30, v14
    v_and_b32 v16, 1, v13
    v_lshlrev_b32 v16, 5, v16
    v_lshl_add_u32 v16, v15, 2, v16
    v_add_u32 v16, s29, v16
    v_lshlrev_b32 v17, 2, v14
    buffer_load_dword v18, v17, s[76:79], 0 offen
    v_lshlrev_b32 v19, 12, v16
    v_lshl_add_u32 v19, v14, 1, v19
    v_lshlrev_b32 v20, 10, v14
    v_lshl_add_u32 v20, v16, 1, v20
    s_mov_b32 s62, 0
    buffer_load_ushort v24, v19, s[16:19], s62 offen
    s_mov_b32 s62, 4096
    buffer_load_ushort v25, v19, s[16:19], s62 offen
    s_mov_b32 s62, 8192
    buffer_load_ushort v26, v19, s[16:19], s62 offen
    s_mov_b32 s62, 12288
    buffer_load_ushort v27, v19, s[16:19], s62 offen
    buffer_load_dwordx2 v[40:41], v20, s[20:23], 0 offen offset:0
    s_mov_b32 s62, 32768
    buffer_load_ushort v28, v19, s[16:19], s62 offen
    s_mov_b32 s62, 36864
    buffer_load_ushort v29, v19, s[16:19], s62 offen
    s_mov_b32 s62, 40960
    buffer_load_ushort v30, v19, s[16:19], s62 offen
    s_mov_b32 s62, 45056
    buffer_load_ushort v31, v19, s[16:19], s62 offen
    buffer_load_dwordx2 v[42:43], v20, s[20:23], 0 offen offset:16
    s_mov_b32 s62, 65536
    buffer_load_ushort v32, v19, s[16:19], s62 offen
    s_mov_b32 s62, 69632
    buffer_load_ushort v33, v19, s[16:19], s62 offen
    s_mov_b32 s62, 73728
    buffer_load_ushort v34, v19, s[16:19], s62 offen
    s_mov_b32 s62, 77824
    buffer_load_ushort v35, v19, s[16:19], s62 offen
    buffer_load_dwordx2 v[44:45], v20, s[20:23], 0 offen offset:32
    s_mov_b32 s62, 98304
    buffer_load_ushort v36, v19, s[16:19], s62 offen
    s_mov_b32 s62, 102400
    buffer_load_ushort v37, v19, s[16:19], s62 offen
    s_mov_b32 s62, 106496
    buffer_load_ushort v38, v19, s[16:19], s62 offen
    s_mov_b32 s62, 110592
    buffer_load_ushort v39, v19, s[16:19], s62 offen
    buffer_load_dwordx2 v[46:47], v20, s[20:23], 0 offen offset:48
    s_waitcnt vmcnt(0)
    v_sub_f32 v21, 1.0, v18
    v_cvt_pk_bf16_f32 v21, v21, v21
    v_lshlrev_b32 v21, 16, v21
    v_cvt_pk_bf16_f32 v2, v64, v65
    v_cvt_pk_bf16_f32 v3, v66, v67
    v_lshlrev_b32 v64, 16, v2
    v_and_b32 v65, 0xffff0000, v2
    v_lshlrev_b32 v66, 16, v3
    v_and_b32 v67, 0xffff0000, v3
    v_mul_f32 v64, v64, v21
    v_mul_f32 v65, v65, v21
    v_mul_f32 v66, v66, v21
    v_mul_f32 v67, v67, v21
    v_cvt_pk_bf16_f32 v2, v64, v65
    v_cvt_pk_bf16_f32 v3, v66, v67
    v_lshlrev_b32 v64, 16, v2
    v_and_b32 v65, 0xffff0000, v2
    v_lshlrev_b32 v66, 16, v3
    v_and_b32 v67, 0xffff0000, v3
    v_lshlrev_b32 v4, 16, v40
    v_and_b32 v5, 0xffff0000, v40
    v_lshlrev_b32 v6, 16, v41
    v_and_b32 v7, 0xffff0000, v41
    v_lshlrev_b32 v24, 16, v24
    v_mul_f32 v4, v4, v24
    v_lshlrev_b32 v25, 16, v25
    v_mul_f32 v5, v5, v25
    v_lshlrev_b32 v26, 16, v26
    v_mul_f32 v6, v6, v26
    v_lshlrev_b32 v27, 16, v27
    v_mul_f32 v7, v7, v27
    v_cvt_pk_bf16_f32 v2, v4, v5
    v_cvt_pk_bf16_f32 v3, v6, v7
    v_lshlrev_b32 v4, 16, v2
    v_and_b32 v5, 0xffff0000, v2
    v_lshlrev_b32 v6, 16, v3
    v_and_b32 v7, 0xffff0000, v3
    v_mul_f32 v4, v4, v18
    v_mul_f32 v5, v5, v18
    v_mul_f32 v6, v6, v18
    v_mul_f32 v7, v7, v18
    v_cvt_pk_bf16_f32 v2, v4, v5
    v_cvt_pk_bf16_f32 v3, v6, v7
    v_lshlrev_b32 v4, 16, v2
    v_and_b32 v5, 0xffff0000, v2
    v_lshlrev_b32 v6, 16, v3
    v_and_b32 v7, 0xffff0000, v3
    v_add_f32 v4, v4, v64
    v_add_f32 v5, v5, v65
    v_add_f32 v6, v6, v66
    v_add_f32 v7, v7, v67
    v_cvt_pk_bf16_f32 v2, v4, v5
    v_cvt_pk_bf16_f32 v3, v6, v7
    buffer_store_dwordx2 v[2:3], v20, s[72:75], 0 offen offset:0
    s_nop 1
    v_cvt_pk_bf16_f32 v2, v68, v69
    v_cvt_pk_bf16_f32 v3, v70, v71
    v_lshlrev_b32 v68, 16, v2
    v_and_b32 v69, 0xffff0000, v2
    v_lshlrev_b32 v70, 16, v3
    v_and_b32 v71, 0xffff0000, v3
    v_mul_f32 v68, v68, v21
    v_mul_f32 v69, v69, v21
    v_mul_f32 v70, v70, v21
    v_mul_f32 v71, v71, v21
    v_cvt_pk_bf16_f32 v2, v68, v69
    v_cvt_pk_bf16_f32 v3, v70, v71
    v_lshlrev_b32 v68, 16, v2
    v_and_b32 v69, 0xffff0000, v2
    v_lshlrev_b32 v70, 16, v3
    v_and_b32 v71, 0xffff0000, v3
    v_lshlrev_b32 v4, 16, v42
    v_and_b32 v5, 0xffff0000, v42
    v_lshlrev_b32 v6, 16, v43
    v_and_b32 v7, 0xffff0000, v43
    v_lshlrev_b32 v28, 16, v28
    v_mul_f32 v4, v4, v28
    v_lshlrev_b32 v29, 16, v29
    v_mul_f32 v5, v5, v29
    v_lshlrev_b32 v30, 16, v30
    v_mul_f32 v6, v6, v30
    v_lshlrev_b32 v31, 16, v31
    v_mul_f32 v7, v7, v31
    v_cvt_pk_bf16_f32 v2, v4, v5
    v_cvt_pk_bf16_f32 v3, v6, v7
    v_lshlrev_b32 v4, 16, v2
    v_and_b32 v5, 0xffff0000, v2
    v_lshlrev_b32 v6, 16, v3
    v_and_b32 v7, 0xffff0000, v3
    v_mul_f32 v4, v4, v18
    v_mul_f32 v5, v5, v18
    v_mul_f32 v6, v6, v18
    v_mul_f32 v7, v7, v18
    v_cvt_pk_bf16_f32 v2, v4, v5
    v_cvt_pk_bf16_f32 v3, v6, v7
    v_lshlrev_b32 v4, 16, v2
    v_and_b32 v5, 0xffff0000, v2
    v_lshlrev_b32 v6, 16, v3
    v_and_b32 v7, 0xffff0000, v3
    v_add_f32 v4, v4, v68
    v_add_f32 v5, v5, v69
    v_add_f32 v6, v6, v70
    v_add_f32 v7, v7, v71
    v_cvt_pk_bf16_f32 v2, v4, v5
    v_cvt_pk_bf16_f32 v3, v6, v7
    buffer_store_dwordx2 v[2:3], v20, s[72:75], 0 offen offset:16
    s_nop 1
    v_cvt_pk_bf16_f32 v2, v72, v73
    v_cvt_pk_bf16_f32 v3, v74, v75
    v_lshlrev_b32 v72, 16, v2
    v_and_b32 v73, 0xffff0000, v2
    v_lshlrev_b32 v74, 16, v3
    v_and_b32 v75, 0xffff0000, v3
    v_mul_f32 v72, v72, v21
    v_mul_f32 v73, v73, v21
    v_mul_f32 v74, v74, v21
    v_mul_f32 v75, v75, v21
    v_cvt_pk_bf16_f32 v2, v72, v73
    v_cvt_pk_bf16_f32 v3, v74, v75
    v_lshlrev_b32 v72, 16, v2
    v_and_b32 v73, 0xffff0000, v2
    v_lshlrev_b32 v74, 16, v3
    v_and_b32 v75, 0xffff0000, v3
    v_lshlrev_b32 v4, 16, v44
    v_and_b32 v5, 0xffff0000, v44
    v_lshlrev_b32 v6, 16, v45
    v_and_b32 v7, 0xffff0000, v45
    v_lshlrev_b32 v32, 16, v32
    v_mul_f32 v4, v4, v32
    v_lshlrev_b32 v33, 16, v33
    v_mul_f32 v5, v5, v33
    v_lshlrev_b32 v34, 16, v34
    v_mul_f32 v6, v6, v34
    v_lshlrev_b32 v35, 16, v35
    v_mul_f32 v7, v7, v35
    v_cvt_pk_bf16_f32 v2, v4, v5
    v_cvt_pk_bf16_f32 v3, v6, v7
    v_lshlrev_b32 v4, 16, v2
    v_and_b32 v5, 0xffff0000, v2
    v_lshlrev_b32 v6, 16, v3
    v_and_b32 v7, 0xffff0000, v3
    v_mul_f32 v4, v4, v18
    v_mul_f32 v5, v5, v18
    v_mul_f32 v6, v6, v18
    v_mul_f32 v7, v7, v18
    v_cvt_pk_bf16_f32 v2, v4, v5
    v_cvt_pk_bf16_f32 v3, v6, v7
    v_lshlrev_b32 v4, 16, v2
    v_and_b32 v5, 0xffff0000, v2
    v_lshlrev_b32 v6, 16, v3
    v_and_b32 v7, 0xffff0000, v3
    v_add_f32 v4, v4, v72
    v_add_f32 v5, v5, v73
    v_add_f32 v6, v6, v74
    v_add_f32 v7, v7, v75
    v_cvt_pk_bf16_f32 v2, v4, v5
    v_cvt_pk_bf16_f32 v3, v6, v7
    buffer_store_dwordx2 v[2:3], v20, s[72:75], 0 offen offset:32
    s_nop 1
    v_cvt_pk_bf16_f32 v2, v76, v77
    v_cvt_pk_bf16_f32 v3, v78, v79
    v_lshlrev_b32 v76, 16, v2
    v_and_b32 v77, 0xffff0000, v2
    v_lshlrev_b32 v78, 16, v3
    v_and_b32 v79, 0xffff0000, v3
    v_mul_f32 v76, v76, v21
    v_mul_f32 v77, v77, v21
    v_mul_f32 v78, v78, v21
    v_mul_f32 v79, v79, v21
    v_cvt_pk_bf16_f32 v2, v76, v77
    v_cvt_pk_bf16_f32 v3, v78, v79
    v_lshlrev_b32 v76, 16, v2
    v_and_b32 v77, 0xffff0000, v2
    v_lshlrev_b32 v78, 16, v3
    v_and_b32 v79, 0xffff0000, v3
    v_lshlrev_b32 v4, 16, v46
    v_and_b32 v5, 0xffff0000, v46
    v_lshlrev_b32 v6, 16, v47
    v_and_b32 v7, 0xffff0000, v47
    v_lshlrev_b32 v36, 16, v36
    v_mul_f32 v4, v4, v36
    v_lshlrev_b32 v37, 16, v37
    v_mul_f32 v5, v5, v37
    v_lshlrev_b32 v38, 16, v38
    v_mul_f32 v6, v6, v38
    v_lshlrev_b32 v39, 16, v39
    v_mul_f32 v7, v7, v39
    v_cvt_pk_bf16_f32 v2, v4, v5
    v_cvt_pk_bf16_f32 v3, v6, v7
    v_lshlrev_b32 v4, 16, v2
    v_and_b32 v5, 0xffff0000, v2
    v_lshlrev_b32 v6, 16, v3
    v_and_b32 v7, 0xffff0000, v3
    v_mul_f32 v4, v4, v18
    v_mul_f32 v5, v5, v18
    v_mul_f32 v6, v6, v18
    v_mul_f32 v7, v7, v18
    v_cvt_pk_bf16_f32 v2, v4, v5
    v_cvt_pk_bf16_f32 v3, v6, v7
    v_lshlrev_b32 v4, 16, v2
    v_and_b32 v5, 0xffff0000, v2
    v_lshlrev_b32 v6, 16, v3
    v_and_b32 v7, 0xffff0000, v3
    v_add_f32 v4, v4, v76
    v_add_f32 v5, v5, v77
    v_add_f32 v6, v6, v78
    v_add_f32 v7, v7, v79
    v_cvt_pk_bf16_f32 v2, v4, v5
    v_cvt_pk_bf16_f32 v3, v6, v7
    buffer_store_dwordx2 v[2:3], v20, s[72:75], 0 offen offset:48
    s_nop 1
    s_endpgm
L_g2_exit:
    s_endpgm
.section .rodata,"a"
.p2align 6
.amdhsa_kernel prep_kernel
  .amdhsa_next_free_vgpr 128
  .amdhsa_next_free_sgpr 102
  .amdhsa_accum_offset 128
  .amdhsa_group_segment_fixed_size 0
  .amdhsa_kernarg_size 112
  .amdhsa_user_sgpr_count 2
  .amdhsa_user_sgpr_kernarg_segment_ptr 1
  .amdhsa_system_sgpr_workgroup_id_x 1
.end_amdhsa_kernel
.text
.section .rodata,"a"
.p2align 6
.amdhsa_kernel mid_kernel
  .amdhsa_next_free_vgpr 140
  .amdhsa_next_free_sgpr 102
  .amdhsa_accum_offset 140
  .amdhsa_group_segment_fixed_size 0
  .amdhsa_kernarg_size 112
  .amdhsa_user_sgpr_count 2
  .amdhsa_user_sgpr_kernarg_segment_ptr 1
  .amdhsa_system_sgpr_workgroup_id_x 1
.end_amdhsa_kernel
.text
.section .rodata,"a"
.p2align 6
.amdhsa_kernel gemm2_kernel
  .amdhsa_next_free_vgpr 80
  .amdhsa_next_free_sgpr 102
  .amdhsa_accum_offset 80
  .amdhsa_group_segment_fixed_size 0
  .amdhsa_kernarg_size 112
  .amdhsa_user_sgpr_count 2
  .amdhsa_user_sgpr_kernarg_segment_ptr 1
  .amdhsa_system_sgpr_workgroup_id_x 1
.end_amdhsa_kernel
.text
```
